```python
import torch

def _softmax(x, axis=-1):
    return torch.softmax(x, dim=axis)
def _gelu(x):
    return torch.nn.functional.gelu(x, approximate="tanh")
def _silu(x):
    return torch.nn.functional.silu(x)
def _sigmoid(x):
    return torch.sigmoid(x)
def _layernorm(x, axis=-1, eps=1e-5):
    m = x.mean(dim=axis, keepdim=True)
    v = x.var(dim=axis, keepdim=True, unbiased=False)
    return (x - m) / torch.sqrt(v + eps)
def _scatter_add(tgt, idx, src, axis=0):
    return tgt.clone().index_add_(axis, idx, src)
def _segment_sum(src, seg, n):
    out = torch.zeros((n,) + src.shape[1:], dtype=src.dtype)
    return out.index_add_(0, seg, src)
def _pad(x, pw):
    flat = tuple(v for pair in reversed(pw) for v in pair)
    return torch.nn.functional.pad(x, flat)

kernel_name = 'concat_heads__gqa_block_cached__gqa_block_cached__near_ridge'

def setup_inputs():

    _w = (lambda a: (lambda t: t.to(torch.bfloat16) if t.is_floating_point() else t)(torch.as_tensor(a)))
    def _A_setup():
        B, Sq, D = 16, 128, 576
        Hq, Hkv, Sk, Dh = 32, 16, 1024, 128
        assert Hq % Hkv == 0, (Hq, Hkv)
        return {
            "x": _w((lambda *s: torch.randn(*s, dtype=torch.bfloat16) * 0.8)(B, Sq, D)),
            "k_cache": _w((lambda *s: torch.randn(*s, dtype=torch.bfloat16) * 0.8)(B, Hkv, Sk, Dh)),
            "v_cache": _w((lambda *s: torch.randn(*s, dtype=torch.bfloat16) * 0.05)(B, Hkv, Sk, Dh)),
            "wq": _w((lambda *s: torch.randn(*s, dtype=torch.bfloat16) * 0.8)(D, Hq * Dh) * (D ** -0.5)),
            "wo": _w((lambda *s: torch.randn(*s, dtype=torch.bfloat16) * 0.05)(Hq * Dh, D) * ((Hq * Dh) ** -0.5)),
        }
    _A_in = _A_setup()

    def _B_setup():
        B, Sq, D = 16, 128, 576
        Hq, Hkv, Sk, Dh = 32, 16, 1024, 128
        assert Hq % Hkv == 0, (Hq, Hkv)
        return {
            "x": _w((lambda *s: torch.randn(*s, dtype=torch.bfloat16) * 0.8)(B, Sq, D)),
            "k_cache": _w((lambda *s: torch.randn(*s, dtype=torch.bfloat16) * 0.8)(B, Hkv, Sk, Dh)),
            "v_cache": _w((lambda *s: torch.randn(*s, dtype=torch.bfloat16) * 0.05)(B, Hkv, Sk, Dh)),
            "wq": _w((lambda *s: torch.randn(*s, dtype=torch.bfloat16) * 0.8)(D, Hq * Dh) * (D ** -0.5)),
            "wo": _w((lambda *s: torch.randn(*s, dtype=torch.bfloat16) * 0.05)(Hq * Dh, D) * ((Hq * Dh) ** -0.5)),
        }
    _B_in = _B_setup()

    return {
        "A_x": _A_in["x"],
        "A_k_cache": _A_in["k_cache"],
        "A_v_cache": _A_in["v_cache"],
        "A_wq": _A_in["wq"],
        "A_wo": _A_in["wo"],
        "B_x": _B_in["x"],
        "B_k_cache": _B_in["k_cache"],
        "B_v_cache": _B_in["v_cache"],
        "B_wq": _B_in["wq"],
        "B_wo": _B_in["wo"],
    }

def reference(A_x, A_k_cache, A_v_cache, A_wq, A_wo, B_x, B_k_cache, B_v_cache, B_wq, B_wo):
    def _A_ref(x, k_cache, v_cache, wq, wo):
        B, Sq, D = x.shape
        Hq, Dh = 32, 128
        Hkv = k_cache.shape[1]
        rep = Hq // Hkv
        q = (lambda x, *d: x.permute(*d))((x @ wq).reshape(B, Sq, Hq, Dh), 0, 2, 1, 3)
        k = (lambda x, n, axis: torch.repeat_interleave(x, n, dim=axis))(k_cache, rep, axis=1)
        v = (lambda x, n, axis: torch.repeat_interleave(x, n, dim=axis))(v_cache, rep, axis=1)
        scores = torch.einsum("bhqd,bhkd->bhqk", q, k) * (Dh ** -0.5)
        p = _softmax(scores, axis=-1)
        o = torch.einsum("bhqk,bhkd->bhqd", p, v)
        return (lambda x, *d: x.permute(*d))(o, 0, 2, 1, 3).reshape(B, Sq, Hq * Dh) @ wo

    def _B_ref(x, k_cache, v_cache, wq, wo):
        B, Sq, D = x.shape
        Hq, Dh = 32, 128
        Hkv = k_cache.shape[1]
        rep = Hq // Hkv
        q = (lambda x, *d: x.permute(*d))((x @ wq).reshape(B, Sq, Hq, Dh), 0, 2, 1, 3)
        k = (lambda x, n, axis: torch.repeat_interleave(x, n, dim=axis))(k_cache, rep, axis=1)
        v = (lambda x, n, axis: torch.repeat_interleave(x, n, dim=axis))(v_cache, rep, axis=1)
        scores = torch.einsum("bhqd,bhkd->bhqk", q, k) * (Dh ** -0.5)
        p = _softmax(scores, axis=-1)
        o = torch.einsum("bhqk,bhkd->bhqd", p, v)
        return (lambda x, *d: x.permute(*d))(o, 0, 2, 1, 3).reshape(B, Sq, Hq * Dh) @ wo

    a = _A_ref(A_x, A_k_cache, A_v_cache, A_wq, A_wo)
    b = _B_ref(B_x, B_k_cache, B_v_cache, B_wq, B_wo)
    return torch.concatenate([a, b], axis=-1)
```

```asm
; @launch kernel=attn_kernel grid=(256,1,1) block=(512,1,1) lds=163840
; @launch kernel=outproj_kernel grid=(256,1,1) block=(256,1,1) lds=151552
.amdgcn_target "amdgcn-amd-amdhsa--gfx950"
.text
.globl attn_kernel
.p2align 8
.type attn_kernel,@function
attn_kernel:
    s_cmp_ge_u32 s2, 256
    s_cbranch_scc1 Lattn_done
    s_load_dwordx16 s[64:79], s[0:1], 0
    s_load_dwordx4 s[80:83], s[0:1], 64
    s_load_dwordx2 s[84:85], s[0:1], 96
    s_and_b32 s50, s2, 7
    s_lshr_b32 s51, s2, 3
    s_lshr_b32 s48, s50, 2
    s_and_b32 s52, s50, 3
    s_lshl_b32 s52, s52, 2
    s_and_b32 s53, s51, 3
    s_add_u32 s46, s52, s53
    s_lshr_b32 s47, s51, 2
    v_lshrrev_b32 v248, 6, v0
    v_and_b32 v249, 63, v0
    v_readfirstlane_b32 s36, v248
    s_waitcnt lgkmcnt(0)
    s_cmp_eq_u32 s48, 0
    s_cselect_b32 s90, s64, s74
    s_cselect_b32 s91, s65, s75
    s_cselect_b32 s92, s66, s76
    s_cselect_b32 s93, s67, s77
    s_cselect_b32 s94, s68, s78
    s_cselect_b32 s95, s69, s79
    s_cselect_b32 s96, s70, s80
    s_cselect_b32 s97, s71, s81
    s_cselect_b32 s98, s72, s82
    s_cselect_b32 s99, s73, s83
    s_mul_i32 s50, s46, 147456
    s_add_u32 s8, s90, s50
    s_addc_u32 s9, s91, 0
    s_and_b32 s9, s9, 0xffff
    s_mov_b32 s10, 147456
    s_mov_b32 s11, 0x20000
    s_lshl_b32 s50, s47, 9
    s_sub_u32 s51, 4718592, s50
    s_add_u32 s12, s96, s50
    s_addc_u32 s13, s97, 0
    s_and_b32 s13, s13, 0xffff
    s_mov_b32 s14, s51
    s_mov_b32 s15, 0x20000
    s_lshl_b32 s51, s48, 24
    s_add_u32 s24, s84, s51
    s_addc_u32 s25, s85, 0
    s_and_b32 s25, s25, 0xffff
    s_mov_b32 s26, 16777216
    s_mov_b32 s27, 0x20000
    s_mov_b32 s28, s98
    s_and_b32 s29, s99, 0xffff
    s_mov_b32 s30, 4718592
    s_mov_b32 s31, 0x20000
    s_mul_i32 s51, s48, 4718592
    s_add_u32 s51, s51, 33554432
    s_add_u32 s32, s84, s51
    s_addc_u32 s33, s85, 0
    s_and_b32 s33, s33, 0xffff
    s_mov_b32 s34, 4718592
    s_mov_b32 s35, 0x20000
    s_lshl_b32 s37, s36, 11
    s_lshr_b32 s44, s36, 2
    s_and_b32 s45, s36, 3
    s_mov_b32 s40, 0x3e0293ee
    s_mov_b32 s41, 0x427af233
    s_mov_b32 s4, 0
Lunit:
    s_lshl_b32 s50, s46, 4
    s_add_u32 s50, s50, s47
    s_lshl_b32 s51, s50, 18
    s_add_u32 s16, s92, s51
    s_addc_u32 s17, s93, 0
    s_and_b32 s17, s17, 0xffff
    s_mov_b32 s18, 262144
    s_mov_b32 s19, 0x20000
    s_add_u32 s20, s94, s51
    s_addc_u32 s21, s95, 0
    s_and_b32 s21, s21, 0xffff
    s_mov_b32 s22, 262144
    s_mov_b32 s23, 0x20000
    s_mov_b32 s42, 0
    s_mov_b32 s59, s50
    v_and_b32 v252, 31, v249
    v_lshrrev_b32 v253, 5, v249
    v_lshrrev_b32 v254, 3, v249
    s_lshl_b32 s54, s36, 4
    v_add_u32 v255, s54, v254
    v_mul_u32_u24 v255, 1152, v255
    v_lshrrev_b32 v254, 1, v254
    v_and_b32 v248, 7, v249
    v_xor_b32 v248, v248, v254
    v_lshl_add_u32 v100, v248, 4, v255
    v_xor_b32 v101, 64, v100
    v_bfe_u32 v248, v249, 1, 3
    v_xor_b32 v248, v248, v253
    v_lshlrev_b32 v248, 4, v248
    v_lshl_add_u32 v248, v252, 7, v248
    s_lshl_b32 s54, s45, 12
    s_add_u32 s54, s54, 131072
    v_add_u32 v96, s54, v248
    v_xor_b32 v97, 32, v96
    v_xor_b32 v98, 64, v96
    v_xor_b32 v99, 96, v96
    s_mul_i32 s54, s36, 192
    v_add_u32 v102, s54, v249
    v_lshlrev_b32 v102, 7, v102
    v_lshrrev_b32 v254, 4, v249
    v_and_b32 v255, 15, v249
    s_lshl_b32 s54, s36, 3
    v_add_u32 v248, s54, v254
    v_and_b32 v250, 15, v248
    v_xor_b32 v250, v250, v255
    v_lshlrev_b32 v250, 4, v250
    v_lshl_add_u32 v245, v248, 8, v250
    v_xor_b32 v246, 64, v245
    v_lshlrev_b32 v250, 2, v254
    v_xor_b32 v250, v250, v255
    v_lshlrev_b32 v250, 4, v250
    v_lshl_add_u32 v247, v248, 8, v250
    v_lshl_add_u32 v244, v248, 13, v250
    v_bfe_u32 v248, v249, 2, 2
    v_bfe_u32 v250, v249, 4, 1
    v_and_b32 v251, 1, v249
    v_lshl_add_u32 v250, v250, 1, v251
    v_lshlrev_b32 v251, 2, v248
    v_xor_b32 v250, v250, v251
    v_lshlrev_b32 v250, 4, v250
    v_bfe_u32 v251, v249, 1, 1
    v_lshl_add_u32 v250, v251, 3, v250
    v_lshl_add_u32 v251, v253, 3, v248
    v_lshl_add_u32 v250, v251, 8, v250
    s_lshl_b32 s54, s44, 16
    v_add_u32 v240, s54, v250
    v_xor_b32 v241, 64, v240
    v_xor_b32 v242, 128, v240
    v_xor_b32 v243, 192, v240
    s_lshr_b32 s54, s2, 4
    s_add_u32 s54, s54, s2
    s_and_b32 s54, s54, 15
    s_lshl_b32 s38, s54, 14
    s_mov_b32 s39, s38
    s_cmp_lg_u32 s4, 0
    s_cbranch_scc1 Lskipinit
    s_add_u32 m0, s37, 131072
    s_mov_b32 s54, 0
    s_mov_b32 s55, 8192
    buffer_load_dwordx4 v100, s[8:11], s54 offen lds
    buffer_load_dwordx4 v101, s[8:11], s55 offen offset:1024 lds
    s_add_u32 m0, s37, 0
    s_mov_b32 s54, 0
    s_mov_b32 s55, 31744
    buffer_load_dwordx4 v244, s[12:15], s54 offen lds
    buffer_load_dwordx4 v244, s[12:15], s55 offen offset:1024 lds
    s_add_u32 m0, s37, 65536
    s_mov_b32 s54, 256
    s_mov_b32 s55, 32000
    buffer_load_dwordx4 v244, s[12:15], s54 offen lds
    buffer_load_dwordx4 v244, s[12:15], s55 offen offset:1024 lds
    s_add_u32 m0, s37, 147456
    s_mov_b32 s54, 128
    s_mov_b32 s55, 8320
    buffer_load_dwordx4 v100, s[8:11], s54 offen lds
    buffer_load_dwordx4 v101, s[8:11], s55 offen offset:1024 lds
    s_add_u32 m0, s37, 16384
    s_mov_b32 s54, 524288
    s_mov_b32 s55, 556032
    buffer_load_dwordx4 v244, s[12:15], s54 offen lds
    buffer_load_dwordx4 v244, s[12:15], s55 offen offset:1024 lds
    s_add_u32 m0, s37, 81920
    s_mov_b32 s54, 524544
    s_mov_b32 s55, 556288
    buffer_load_dwordx4 v244, s[12:15], s54 offen lds
    buffer_load_dwordx4 v244, s[12:15], s55 offen offset:1024 lds
    s_add_u32 m0, s37, 32768
    s_mov_b32 s54, 1048576
    s_mov_b32 s55, 1080320
    buffer_load_dwordx4 v244, s[12:15], s54 offen lds
    buffer_load_dwordx4 v244, s[12:15], s55 offen offset:1024 lds
Lskipinit:
    s_barrier
    s_mov_b32 s54, 0
    buffer_load_dword v104, v102, s[8:11], s54 offen
    s_mov_b32 s54, 8192
    buffer_load_dword v105, v102, s[8:11], s54 offen
    s_mov_b32 s54, 16384
    buffer_load_dword v106, v102, s[8:11], s54 offen
    v_mov_b32 v0, 0
    v_mov_b32 v1, 0
    v_mov_b32 v2, 0
    v_mov_b32 v3, 0
    v_mov_b32 v4, 0
    v_mov_b32 v5, 0
    v_mov_b32 v6, 0
    v_mov_b32 v7, 0
    v_mov_b32 v8, 0
    v_mov_b32 v9, 0
    v_mov_b32 v10, 0
    v_mov_b32 v11, 0
    v_mov_b32 v12, 0
    v_mov_b32 v13, 0
    v_mov_b32 v14, 0
    v_mov_b32 v15, 0
    v_mov_b32 v16, 0
    v_mov_b32 v17, 0
    v_mov_b32 v18, 0
    v_mov_b32 v19, 0
    v_mov_b32 v20, 0
    v_mov_b32 v21, 0
    v_mov_b32 v22, 0
    v_mov_b32 v23, 0
    v_mov_b32 v24, 0
    v_mov_b32 v25, 0
    v_mov_b32 v26, 0
    v_mov_b32 v27, 0
    v_mov_b32 v28, 0
    v_mov_b32 v29, 0
    v_mov_b32 v30, 0
    v_mov_b32 v31, 0
    v_mov_b32 v32, 0
    v_mov_b32 v33, 0
    v_mov_b32 v34, 0
    v_mov_b32 v35, 0
    v_mov_b32 v36, 0
    v_mov_b32 v37, 0
    v_mov_b32 v38, 0
    v_mov_b32 v39, 0
    v_mov_b32 v40, 0
    v_mov_b32 v41, 0
    v_mov_b32 v42, 0
    v_mov_b32 v43, 0
    v_mov_b32 v44, 0
    v_mov_b32 v45, 0
    v_mov_b32 v46, 0
    v_mov_b32 v47, 0
    v_mov_b32 v48, 0
    v_mov_b32 v49, 0
    v_mov_b32 v50, 0
    v_mov_b32 v51, 0
    v_mov_b32 v52, 0
    v_mov_b32 v53, 0
    v_mov_b32 v54, 0
    v_mov_b32 v55, 0
    v_mov_b32 v56, 0
    v_mov_b32 v57, 0
    v_mov_b32 v58, 0
    v_mov_b32 v59, 0
    v_mov_b32 v60, 0
    v_mov_b32 v61, 0
    v_mov_b32 v62, 0
    v_mov_b32 v63, 0
    s_waitcnt vmcnt(11) lgkmcnt(0)
    s_barrier
    s_add_u32 m0, s37, 98304
    s_mov_b32 s54, 1048832
    s_mov_b32 s55, 1080576
    buffer_load_dwordx4 v244, s[12:15], s54 offen lds
    buffer_load_dwordx4 v244, s[12:15], s55 offen offset:1024 lds
    s_add_u32 m0, s37, 49152
    s_mov_b32 s54, 1572864
    s_mov_b32 s55, 1604608
    buffer_load_dwordx4 v244, s[12:15], s54 offen lds
    buffer_load_dwordx4 v244, s[12:15], s55 offen offset:1024 lds
    ds_read_b128 v[64:67], v96 offset:0
    ds_read_b64_tr_b16 v[208:209], v240 offset:0
    ds_read_b64_tr_b16 v[210:211], v240 offset:1024
    ds_read_b64_tr_b16 v[212:213], v241 offset:0
    ds_read_b64_tr_b16 v[214:215], v241 offset:1024
    ds_read_b64_tr_b16 v[216:217], v242 offset:0
    ds_read_b64_tr_b16 v[218:219], v242 offset:1024
    ds_read_b64_tr_b16 v[220:221], v243 offset:0
    ds_read_b64_tr_b16 v[222:223], v243 offset:1024
    ds_read_b128 v[68:71], v97 offset:0
    ds_read_b64_tr_b16 v[224:225], v240 offset:4096
    ds_read_b64_tr_b16 v[226:227], v240 offset:5120
    ds_read_b64_tr_b16 v[228:229], v241 offset:4096
    ds_read_b64_tr_b16 v[230:231], v241 offset:5120
    s_waitcnt lgkmcnt(11)
    v_mfma_f32_32x32x16_bf16 v[0:15], v[208:211], v[64:67], v[0:15]
    ds_read_b64_tr_b16 v[232:233], v242 offset:4096
    ds_read_b64_tr_b16 v[234:235], v242 offset:5120
    s_waitcnt lgkmcnt(11)
    v_mfma_f32_32x32x16_bf16 v[16:31], v[212:215], v[64:67], v[16:31]
    ds_read_b64_tr_b16 v[236:237], v243 offset:4096
    ds_read_b64_tr_b16 v[238:239], v243 offset:5120
    s_waitcnt lgkmcnt(11)
    v_mfma_f32_32x32x16_bf16 v[32:47], v[216:219], v[64:67], v[32:47]
    ds_read_b128 v[72:75], v98 offset:0
    ds_read_b64_tr_b16 v[208:209], v240 offset:8192
    ds_read_b64_tr_b16 v[210:211], v240 offset:9216
    s_waitcnt lgkmcnt(12)
    v_mfma_f32_32x32x16_bf16 v[48:63], v[220:223], v[64:67], v[48:63]
    ds_read_b64_tr_b16 v[212:213], v241 offset:8192
    ds_read_b64_tr_b16 v[214:215], v241 offset:9216
    s_waitcnt lgkmcnt(11)
    v_mfma_f32_32x32x16_bf16 v[0:15], v[224:227], v[68:71], v[0:15]
    ds_read_b64_tr_b16 v[216:217], v242 offset:8192
    ds_read_b64_tr_b16 v[218:219], v242 offset:9216
    s_waitcnt lgkmcnt(11)
    v_mfma_f32_32x32x16_bf16 v[16:31], v[228:231], v[68:71], v[16:31]
    ds_read_b64_tr_b16 v[220:221], v243 offset:8192
    ds_read_b64_tr_b16 v[222:223], v243 offset:9216
    s_waitcnt lgkmcnt(11)
    v_mfma_f32_32x32x16_bf16 v[32:47], v[232:235], v[68:71], v[32:47]
    ds_read_b128 v[76:79], v99 offset:0
    ds_read_b64_tr_b16 v[224:225], v240 offset:12288
    ds_read_b64_tr_b16 v[226:227], v240 offset:13312
    s_waitcnt lgkmcnt(12)
    v_mfma_f32_32x32x16_bf16 v[48:63], v[236:239], v[68:71], v[48:63]
    ds_read_b64_tr_b16 v[228:229], v241 offset:12288
    ds_read_b64_tr_b16 v[230:231], v241 offset:13312
    s_waitcnt lgkmcnt(11)
    v_mfma_f32_32x32x16_bf16 v[0:15], v[208:211], v[72:75], v[0:15]
    ds_read_b64_tr_b16 v[232:233], v242 offset:12288
    ds_read_b64_tr_b16 v[234:235], v242 offset:13312
    s_waitcnt lgkmcnt(11)
    v_mfma_f32_32x32x16_bf16 v[16:31], v[212:215], v[72:75], v[16:31]
    ds_read_b64_tr_b16 v[236:237], v243 offset:12288
    ds_read_b64_tr_b16 v[238:239], v243 offset:13312
    s_waitcnt lgkmcnt(11)
    v_mfma_f32_32x32x16_bf16 v[32:47], v[216:219], v[72:75], v[32:47]
    s_waitcnt lgkmcnt(9)
    v_mfma_f32_32x32x16_bf16 v[48:63], v[220:223], v[72:75], v[48:63]
    s_waitcnt vmcnt(9) lgkmcnt(0)
    s_barrier
    s_add_u32 m0, s37, 131072
    s_mov_b32 s54, 256
    s_mov_b32 s55, 8448
    buffer_load_dwordx4 v100, s[8:11], s54 offen lds
    buffer_load_dwordx4 v101, s[8:11], s55 offen offset:1024 lds
    s_add_u32 m0, s37, 114688
    s_mov_b32 s54, 1573120
    s_mov_b32 s55, 1604864
    buffer_load_dwordx4 v244, s[12:15], s54 offen lds
    buffer_load_dwordx4 v244, s[12:15], s55 offen offset:1024 lds
    s_add_u32 m0, s37, 0
    s_mov_b32 s54, 2097152
    s_mov_b32 s55, 2128896
    buffer_load_dwordx4 v244, s[12:15], s54 offen lds
    buffer_load_dwordx4 v244, s[12:15], s55 offen offset:1024 lds
    ds_read_b128 v[80:83], v96 offset:16384
    ds_read_b64_tr_b16 v[208:209], v240 offset:16384
    ds_read_b64_tr_b16 v[210:211], v240 offset:17408
    ds_read_b64_tr_b16 v[212:213], v241 offset:16384
    ds_read_b64_tr_b16 v[214:215], v241 offset:17408
    v_mfma_f32_32x32x16_bf16 v[0:15], v[224:227], v[76:79], v[0:15]
    ds_read_b64_tr_b16 v[216:217], v242 offset:16384
    ds_read_b64_tr_b16 v[218:219], v242 offset:17408
    v_mfma_f32_32x32x16_bf16 v[16:31], v[228:231], v[76:79], v[16:31]
    ds_read_b64_tr_b16 v[220:221], v243 offset:16384
    ds_read_b64_tr_b16 v[222:223], v243 offset:17408
    v_mfma_f32_32x32x16_bf16 v[32:47], v[232:235], v[76:79], v[32:47]
    ds_read_b128 v[84:87], v97 offset:16384
    ds_read_b64_tr_b16 v[224:225], v240 offset:20480
    ds_read_b64_tr_b16 v[226:227], v240 offset:21504
    v_mfma_f32_32x32x16_bf16 v[48:63], v[236:239], v[76:79], v[48:63]
    ds_read_b64_tr_b16 v[228:229], v241 offset:20480
    ds_read_b64_tr_b16 v[230:231], v241 offset:21504
    s_waitcnt lgkmcnt(11)
    v_mfma_f32_32x32x16_bf16 v[0:15], v[208:211], v[80:83], v[0:15]
    ds_read_b64_tr_b16 v[232:233], v242 offset:20480
    ds_read_b64_tr_b16 v[234:235], v242 offset:21504
    s_waitcnt lgkmcnt(11)
    v_mfma_f32_32x32x16_bf16 v[16:31], v[212:215], v[80:83], v[16:31]
    ds_read_b64_tr_b16 v[236:237], v243 offset:20480
    ds_read_b64_tr_b16 v[238:239], v243 offset:21504
    s_waitcnt lgkmcnt(11)
    v_mfma_f32_32x32x16_bf16 v[32:47], v[216:219], v[80:83], v[32:47]
    ds_read_b128 v[88:91], v98 offset:16384
    ds_read_b64_tr_b16 v[208:209], v240 offset:24576
    ds_read_b64_tr_b16 v[210:211], v240 offset:25600
    s_waitcnt lgkmcnt(12)
    v_mfma_f32_32x32x16_bf16 v[48:63], v[220:223], v[80:83], v[48:63]
    ds_read_b64_tr_b16 v[212:213], v241 offset:24576
    ds_read_b64_tr_b16 v[214:215], v241 offset:25600
    s_waitcnt lgkmcnt(11)
    v_mfma_f32_32x32x16_bf16 v[0:15], v[224:227], v[84:87], v[0:15]
    ds_read_b64_tr_b16 v[216:217], v242 offset:24576
    ds_read_b64_tr_b16 v[218:219], v242 offset:25600
    s_waitcnt lgkmcnt(11)
    v_mfma_f32_32x32x16_bf16 v[16:31], v[228:231], v[84:87], v[16:31]
    ds_read_b64_tr_b16 v[220:221], v243 offset:24576
    ds_read_b64_tr_b16 v[222:223], v243 offset:25600
    s_waitcnt lgkmcnt(11)
    v_mfma_f32_32x32x16_bf16 v[32:47], v[232:235], v[84:87], v[32:47]
    ds_read_b128 v[92:95], v99 offset:16384
    ds_read_b64_tr_b16 v[224:225], v240 offset:28672
    ds_read_b64_tr_b16 v[226:227], v240 offset:29696
    s_waitcnt lgkmcnt(12)
    v_mfma_f32_32x32x16_bf16 v[48:63], v[236:239], v[84:87], v[48:63]
    ds_read_b64_tr_b16 v[228:229], v241 offset:28672
    ds_read_b64_tr_b16 v[230:231], v241 offset:29696
    s_waitcnt lgkmcnt(11)
    v_mfma_f32_32x32x16_bf16 v[0:15], v[208:211], v[88:91], v[0:15]
    ds_read_b64_tr_b16 v[232:233], v242 offset:28672
    ds_read_b64_tr_b16 v[234:235], v242 offset:29696
    s_waitcnt lgkmcnt(11)
    v_mfma_f32_32x32x16_bf16 v[16:31], v[212:215], v[88:91], v[16:31]
    ds_read_b64_tr_b16 v[236:237], v243 offset:28672
    ds_read_b64_tr_b16 v[238:239], v243 offset:29696
    s_waitcnt lgkmcnt(11)
    v_mfma_f32_32x32x16_bf16 v[32:47], v[216:219], v[88:91], v[32:47]
    s_waitcnt lgkmcnt(9)
    v_mfma_f32_32x32x16_bf16 v[48:63], v[220:223], v[88:91], v[48:63]
    s_waitcnt vmcnt(4) lgkmcnt(0)
    s_barrier
    s_add_u32 m0, s37, 147456
    s_mov_b32 s54, 384
    s_mov_b32 s55, 8576
    buffer_load_dwordx4 v100, s[8:11], s54 offen lds
    buffer_load_dwordx4 v101, s[8:11], s55 offen offset:1024 lds
    s_add_u32 m0, s37, 65536
    s_mov_b32 s54, 2097408
    s_mov_b32 s55, 2129152
    buffer_load_dwordx4 v244, s[12:15], s54 offen lds
    buffer_load_dwordx4 v244, s[12:15], s55 offen offset:1024 lds
    s_add_u32 m0, s37, 16384
    s_mov_b32 s54, 2621440
    s_mov_b32 s55, 2653184
    buffer_load_dwordx4 v244, s[12:15], s54 offen lds
    buffer_load_dwordx4 v244, s[12:15], s55 offen offset:1024 lds
    ds_read_b128 v[64:67], v96 offset:0
    ds_read_b64_tr_b16 v[208:209], v240 offset:32768
    ds_read_b64_tr_b16 v[210:211], v240 offset:33792
    ds_read_b64_tr_b16 v[212:213], v241 offset:32768
    ds_read_b64_tr_b16 v[214:215], v241 offset:33792
    v_mfma_f32_32x32x16_bf16 v[0:15], v[224:227], v[92:95], v[0:15]
    ds_read_b64_tr_b16 v[216:217], v242 offset:32768
    ds_read_b64_tr_b16 v[218:219], v242 offset:33792
    v_mfma_f32_32x32x16_bf16 v[16:31], v[228:231], v[92:95], v[16:31]
    ds_read_b64_tr_b16 v[220:221], v243 offset:32768
    ds_read_b64_tr_b16 v[222:223], v243 offset:33792
    v_mfma_f32_32x32x16_bf16 v[32:47], v[232:235], v[92:95], v[32:47]
    ds_read_b128 v[68:71], v97 offset:0
    ds_read_b64_tr_b16 v[224:225], v240 offset:36864
    ds_read_b64_tr_b16 v[226:227], v240 offset:37888
    v_mfma_f32_32x32x16_bf16 v[48:63], v[236:239], v[92:95], v[48:63]
    ds_read_b64_tr_b16 v[228:229], v241 offset:36864
    ds_read_b64_tr_b16 v[230:231], v241 offset:37888
    s_waitcnt lgkmcnt(11)
    v_mfma_f32_32x32x16_bf16 v[0:15], v[208:211], v[64:67], v[0:15]
    ds_read_b64_tr_b16 v[232:233], v242 offset:36864
    ds_read_b64_tr_b16 v[234:235], v242 offset:37888
    s_waitcnt lgkmcnt(11)
    v_mfma_f32_32x32x16_bf16 v[16:31], v[212:215], v[64:67], v[16:31]
    ds_read_b64_tr_b16 v[236:237], v243 offset:36864
    ds_read_b64_tr_b16 v[238:239], v243 offset:37888
    s_waitcnt lgkmcnt(11)
    v_mfma_f32_32x32x16_bf16 v[32:47], v[216:219], v[64:67], v[32:47]
    ds_read_b128 v[72:75], v98 offset:0
    ds_read_b64_tr_b16 v[208:209], v240 offset:40960
    ds_read_b64_tr_b16 v[210:211], v240 offset:41984
    s_waitcnt lgkmcnt(12)
    v_mfma_f32_32x32x16_bf16 v[48:63], v[220:223], v[64:67], v[48:63]
    ds_read_b64_tr_b16 v[212:213], v241 offset:40960
    ds_read_b64_tr_b16 v[214:215], v241 offset:41984
    s_waitcnt lgkmcnt(11)
    v_mfma_f32_32x32x16_bf16 v[0:15], v[224:227], v[68:71], v[0:15]
    ds_read_b64_tr_b16 v[216:217], v242 offset:40960
    ds_read_b64_tr_b16 v[218:219], v242 offset:41984
    s_waitcnt lgkmcnt(11)
    v_mfma_f32_32x32x16_bf16 v[16:31], v[228:231], v[68:71], v[16:31]
    ds_read_b64_tr_b16 v[220:221], v243 offset:40960
    ds_read_b64_tr_b16 v[222:223], v243 offset:41984
    s_waitcnt lgkmcnt(11)
    v_mfma_f32_32x32x16_bf16 v[32:47], v[232:235], v[68:71], v[32:47]
    ds_read_b128 v[76:79], v99 offset:0
    ds_read_b64_tr_b16 v[224:225], v240 offset:45056
    ds_read_b64_tr_b16 v[226:227], v240 offset:46080
    s_waitcnt lgkmcnt(12)
    v_mfma_f32_32x32x16_bf16 v[48:63], v[236:239], v[68:71], v[48:63]
    ds_read_b64_tr_b16 v[228:229], v241 offset:45056
    ds_read_b64_tr_b16 v[230:231], v241 offset:46080
    s_waitcnt lgkmcnt(11)
    v_mfma_f32_32x32x16_bf16 v[0:15], v[208:211], v[72:75], v[0:15]
    ds_read_b64_tr_b16 v[232:233], v242 offset:45056
    ds_read_b64_tr_b16 v[234:235], v242 offset:46080
    s_waitcnt lgkmcnt(11)
    v_mfma_f32_32x32x16_bf16 v[16:31], v[212:215], v[72:75], v[16:31]
    ds_read_b64_tr_b16 v[236:237], v243 offset:45056
    ds_read_b64_tr_b16 v[238:239], v243 offset:46080
    s_waitcnt lgkmcnt(11)
    v_mfma_f32_32x32x16_bf16 v[32:47], v[216:219], v[72:75], v[32:47]
    s_waitcnt lgkmcnt(9)
    v_mfma_f32_32x32x16_bf16 v[48:63], v[220:223], v[72:75], v[48:63]
    s_waitcnt vmcnt(4) lgkmcnt(0)
    s_barrier
    s_add_u32 m0, s37, 131072
    s_mov_b32 s54, 512
    s_mov_b32 s55, 8704
    buffer_load_dwordx4 v100, s[8:11], s54 offen lds
    buffer_load_dwordx4 v101, s[8:11], s55 offen offset:1024 lds
    s_add_u32 m0, s37, 81920
    s_mov_b32 s54, 2621696
    s_mov_b32 s55, 2653440
    buffer_load_dwordx4 v244, s[12:15], s54 offen lds
    buffer_load_dwordx4 v244, s[12:15], s55 offen offset:1024 lds
    s_add_u32 m0, s37, 32768
    s_mov_b32 s54, 3145728
    s_mov_b32 s55, 3177472
    buffer_load_dwordx4 v244, s[12:15], s54 offen lds
    buffer_load_dwordx4 v244, s[12:15], s55 offen offset:1024 lds
    ds_read_b128 v[80:83], v96 offset:16384
    ds_read_b64_tr_b16 v[208:209], v240 offset:49152
    ds_read_b64_tr_b16 v[210:211], v240 offset:50176
    ds_read_b64_tr_b16 v[212:213], v241 offset:49152
    ds_read_b64_tr_b16 v[214:215], v241 offset:50176
    v_mfma_f32_32x32x16_bf16 v[0:15], v[224:227], v[76:79], v[0:15]
    ds_read_b64_tr_b16 v[216:217], v242 offset:49152
    ds_read_b64_tr_b16 v[218:219], v242 offset:50176
    v_mfma_f32_32x32x16_bf16 v[16:31], v[228:231], v[76:79], v[16:31]
    ds_read_b64_tr_b16 v[220:221], v243 offset:49152
    ds_read_b64_tr_b16 v[222:223], v243 offset:50176
    v_mfma_f32_32x32x16_bf16 v[32:47], v[232:235], v[76:79], v[32:47]
    ds_read_b128 v[84:87], v97 offset:16384
    ds_read_b64_tr_b16 v[224:225], v240 offset:53248
    ds_read_b64_tr_b16 v[226:227], v240 offset:54272
    v_mfma_f32_32x32x16_bf16 v[48:63], v[236:239], v[76:79], v[48:63]
    ds_read_b64_tr_b16 v[228:229], v241 offset:53248
    ds_read_b64_tr_b16 v[230:231], v241 offset:54272
    s_waitcnt lgkmcnt(11)
    v_mfma_f32_32x32x16_bf16 v[0:15], v[208:211], v[80:83], v[0:15]
    ds_read_b64_tr_b16 v[232:233], v242 offset:53248
    ds_read_b64_tr_b16 v[234:235], v242 offset:54272
    s_waitcnt lgkmcnt(11)
    v_mfma_f32_32x32x16_bf16 v[16:31], v[212:215], v[80:83], v[16:31]
    ds_read_b64_tr_b16 v[236:237], v243 offset:53248
    ds_read_b64_tr_b16 v[238:239], v243 offset:54272
    s_waitcnt lgkmcnt(11)
    v_mfma_f32_32x32x16_bf16 v[32:47], v[216:219], v[80:83], v[32:47]
    ds_read_b128 v[88:91], v98 offset:16384
    ds_read_b64_tr_b16 v[208:209], v240 offset:57344
    ds_read_b64_tr_b16 v[210:211], v240 offset:58368
    s_waitcnt lgkmcnt(12)
    v_mfma_f32_32x32x16_bf16 v[48:63], v[220:223], v[80:83], v[48:63]
    ds_read_b64_tr_b16 v[212:213], v241 offset:57344
    ds_read_b64_tr_b16 v[214:215], v241 offset:58368
    s_waitcnt lgkmcnt(11)
    v_mfma_f32_32x32x16_bf16 v[0:15], v[224:227], v[84:87], v[0:15]
    ds_read_b64_tr_b16 v[216:217], v242 offset:57344
    ds_read_b64_tr_b16 v[218:219], v242 offset:58368
    s_waitcnt lgkmcnt(11)
    v_mfma_f32_32x32x16_bf16 v[16:31], v[228:231], v[84:87], v[16:31]
    ds_read_b64_tr_b16 v[220:221], v243 offset:57344
    ds_read_b64_tr_b16 v[222:223], v243 offset:58368
    s_waitcnt lgkmcnt(11)
    v_mfma_f32_32x32x16_bf16 v[32:47], v[232:235], v[84:87], v[32:47]
    ds_read_b128 v[92:95], v99 offset:16384
    ds_read_b64_tr_b16 v[224:225], v240 offset:61440
    ds_read_b64_tr_b16 v[226:227], v240 offset:62464
    s_waitcnt lgkmcnt(12)
    v_mfma_f32_32x32x16_bf16 v[48:63], v[236:239], v[84:87], v[48:63]
    ds_read_b64_tr_b16 v[228:229], v241 offset:61440
    ds_read_b64_tr_b16 v[230:231], v241 offset:62464
    s_waitcnt lgkmcnt(11)
    v_mfma_f32_32x32x16_bf16 v[0:15], v[208:211], v[88:91], v[0:15]
    ds_read_b64_tr_b16 v[232:233], v242 offset:61440
    ds_read_b64_tr_b16 v[234:235], v242 offset:62464
    s_waitcnt lgkmcnt(11)
    v_mfma_f32_32x32x16_bf16 v[16:31], v[212:215], v[88:91], v[16:31]
    ds_read_b64_tr_b16 v[236:237], v243 offset:61440
    ds_read_b64_tr_b16 v[238:239], v243 offset:62464
    s_waitcnt lgkmcnt(11)
    v_mfma_f32_32x32x16_bf16 v[32:47], v[216:219], v[88:91], v[32:47]
    s_waitcnt lgkmcnt(9)
    v_mfma_f32_32x32x16_bf16 v[48:63], v[220:223], v[88:91], v[48:63]
    s_waitcnt vmcnt(4) lgkmcnt(0)
    s_barrier
    s_add_u32 m0, s37, 147456
    s_mov_b32 s54, 640
    s_mov_b32 s55, 8832
    buffer_load_dwordx4 v100, s[8:11], s54 offen lds
    buffer_load_dwordx4 v101, s[8:11], s55 offen offset:1024 lds
    s_add_u32 m0, s37, 98304
    s_mov_b32 s54, 3145984
    s_mov_b32 s55, 3177728
    buffer_load_dwordx4 v244, s[12:15], s54 offen lds
    buffer_load_dwordx4 v244, s[12:15], s55 offen offset:1024 lds
    s_add_u32 m0, s37, 49152
    s_mov_b32 s54, 3670016
    s_mov_b32 s55, 3701760
    buffer_load_dwordx4 v244, s[12:15], s54 offen lds
    buffer_load_dwordx4 v244, s[12:15], s55 offen offset:1024 lds
    ds_read_b128 v[64:67], v96 offset:0
    ds_read_b64_tr_b16 v[208:209], v240 offset:0
    ds_read_b64_tr_b16 v[210:211], v240 offset:1024
    ds_read_b64_tr_b16 v[212:213], v241 offset:0
    ds_read_b64_tr_b16 v[214:215], v241 offset:1024
    v_mfma_f32_32x32x16_bf16 v[0:15], v[224:227], v[92:95], v[0:15]
    ds_read_b64_tr_b16 v[216:217], v242 offset:0
    ds_read_b64_tr_b16 v[218:219], v242 offset:1024
    v_mfma_f32_32x32x16_bf16 v[16:31], v[228:231], v[92:95], v[16:31]
    ds_read_b64_tr_b16 v[220:221], v243 offset:0
    ds_read_b64_tr_b16 v[222:223], v243 offset:1024
    v_mfma_f32_32x32x16_bf16 v[32:47], v[232:235], v[92:95], v[32:47]
    ds_read_b128 v[68:71], v97 offset:0
    ds_read_b64_tr_b16 v[224:225], v240 offset:4096
    ds_read_b64_tr_b16 v[226:227], v240 offset:5120
    v_mfma_f32_32x32x16_bf16 v[48:63], v[236:239], v[92:95], v[48:63]
    ds_read_b64_tr_b16 v[228:229], v241 offset:4096
    ds_read_b64_tr_b16 v[230:231], v241 offset:5120
    s_waitcnt lgkmcnt(11)
    v_mfma_f32_32x32x16_bf16 v[0:15], v[208:211], v[64:67], v[0:15]
    ds_read_b64_tr_b16 v[232:233], v242 offset:4096
    ds_read_b64_tr_b16 v[234:235], v242 offset:5120
    s_waitcnt lgkmcnt(11)
    v_mfma_f32_32x32x16_bf16 v[16:31], v[212:215], v[64:67], v[16:31]
    ds_read_b64_tr_b16 v[236:237], v243 offset:4096
    ds_read_b64_tr_b16 v[238:239], v243 offset:5120
    s_waitcnt lgkmcnt(11)
    v_mfma_f32_32x32x16_bf16 v[32:47], v[216:219], v[64:67], v[32:47]
    ds_read_b128 v[72:75], v98 offset:0
    ds_read_b64_tr_b16 v[208:209], v240 offset:8192
    ds_read_b64_tr_b16 v[210:211], v240 offset:9216
    s_waitcnt lgkmcnt(12)
    v_mfma_f32_32x32x16_bf16 v[48:63], v[220:223], v[64:67], v[48:63]
    ds_read_b64_tr_b16 v[212:213], v241 offset:8192
    ds_read_b64_tr_b16 v[214:215], v241 offset:9216
    s_waitcnt lgkmcnt(11)
    v_mfma_f32_32x32x16_bf16 v[0:15], v[224:227], v[68:71], v[0:15]
    ds_read_b64_tr_b16 v[216:217], v242 offset:8192
    ds_read_b64_tr_b16 v[218:219], v242 offset:9216
    s_waitcnt lgkmcnt(11)
    v_mfma_f32_32x32x16_bf16 v[16:31], v[228:231], v[68:71], v[16:31]
    ds_read_b64_tr_b16 v[220:221], v243 offset:8192
    ds_read_b64_tr_b16 v[222:223], v243 offset:9216
    s_waitcnt lgkmcnt(11)
    v_mfma_f32_32x32x16_bf16 v[32:47], v[232:235], v[68:71], v[32:47]
    ds_read_b128 v[76:79], v99 offset:0
    ds_read_b64_tr_b16 v[224:225], v240 offset:12288
    ds_read_b64_tr_b16 v[226:227], v240 offset:13312
    s_waitcnt lgkmcnt(12)
    v_mfma_f32_32x32x16_bf16 v[48:63], v[236:239], v[68:71], v[48:63]
    ds_read_b64_tr_b16 v[228:229], v241 offset:12288
    ds_read_b64_tr_b16 v[230:231], v241 offset:13312
    s_waitcnt lgkmcnt(11)
    v_mfma_f32_32x32x16_bf16 v[0:15], v[208:211], v[72:75], v[0:15]
    ds_read_b64_tr_b16 v[232:233], v242 offset:12288
    ds_read_b64_tr_b16 v[234:235], v242 offset:13312
    s_waitcnt lgkmcnt(11)
    v_mfma_f32_32x32x16_bf16 v[16:31], v[212:215], v[72:75], v[16:31]
    ds_read_b64_tr_b16 v[236:237], v243 offset:12288
    ds_read_b64_tr_b16 v[238:239], v243 offset:13312
    s_waitcnt lgkmcnt(11)
    v_mfma_f32_32x32x16_bf16 v[32:47], v[216:219], v[72:75], v[32:47]
    s_waitcnt lgkmcnt(9)
    v_mfma_f32_32x32x16_bf16 v[48:63], v[220:223], v[72:75], v[48:63]
    s_waitcnt vmcnt(4) lgkmcnt(0)
    s_barrier
    s_add_u32 m0, s37, 131072
    s_mov_b32 s54, 768
    s_mov_b32 s55, 8960
    buffer_load_dwordx4 v100, s[8:11], s54 offen lds
    buffer_load_dwordx4 v101, s[8:11], s55 offen offset:1024 lds
    s_add_u32 m0, s37, 114688
    s_mov_b32 s54, 3670272
    s_mov_b32 s55, 3702016
    buffer_load_dwordx4 v244, s[12:15], s54 offen lds
    buffer_load_dwordx4 v244, s[12:15], s55 offen offset:1024 lds
    s_add_u32 m0, s37, 0
    s_mov_b32 s54, 4194304
    s_mov_b32 s55, 4226048
    buffer_load_dwordx4 v244, s[12:15], s54 offen lds
    buffer_load_dwordx4 v244, s[12:15], s55 offen offset:1024 lds
    ds_read_b128 v[80:83], v96 offset:16384
    ds_read_b64_tr_b16 v[208:209], v240 offset:16384
    ds_read_b64_tr_b16 v[210:211], v240 offset:17408
    ds_read_b64_tr_b16 v[212:213], v241 offset:16384
    ds_read_b64_tr_b16 v[214:215], v241 offset:17408
    v_mfma_f32_32x32x16_bf16 v[0:15], v[224:227], v[76:79], v[0:15]
    ds_read_b64_tr_b16 v[216:217], v242 offset:16384
    ds_read_b64_tr_b16 v[218:219], v242 offset:17408
    v_mfma_f32_32x32x16_bf16 v[16:31], v[228:231], v[76:79], v[16:31]
    ds_read_b64_tr_b16 v[220:221], v243 offset:16384
    ds_read_b64_tr_b16 v[222:223], v243 offset:17408
    v_mfma_f32_32x32x16_bf16 v[32:47], v[232:235], v[76:79], v[32:47]
    ds_read_b128 v[84:87], v97 offset:16384
    ds_read_b64_tr_b16 v[224:225], v240 offset:20480
    ds_read_b64_tr_b16 v[226:227], v240 offset:21504
    v_mfma_f32_32x32x16_bf16 v[48:63], v[236:239], v[76:79], v[48:63]
    ds_read_b64_tr_b16 v[228:229], v241 offset:20480
    ds_read_b64_tr_b16 v[230:231], v241 offset:21504
    s_waitcnt lgkmcnt(11)
    v_mfma_f32_32x32x16_bf16 v[0:15], v[208:211], v[80:83], v[0:15]
    ds_read_b64_tr_b16 v[232:233], v242 offset:20480
    ds_read_b64_tr_b16 v[234:235], v242 offset:21504
    s_waitcnt lgkmcnt(11)
    v_mfma_f32_32x32x16_bf16 v[16:31], v[212:215], v[80:83], v[16:31]
    ds_read_b64_tr_b16 v[236:237], v243 offset:20480
    ds_read_b64_tr_b16 v[238:239], v243 offset:21504
    s_waitcnt lgkmcnt(11)
    v_mfma_f32_32x32x16_bf16 v[32:47], v[216:219], v[80:83], v[32:47]
    ds_read_b128 v[88:91], v98 offset:16384
    ds_read_b64_tr_b16 v[208:209], v240 offset:24576
    ds_read_b64_tr_b16 v[210:211], v240 offset:25600
    s_waitcnt lgkmcnt(12)
    v_mfma_f32_32x32x16_bf16 v[48:63], v[220:223], v[80:83], v[48:63]
    ds_read_b64_tr_b16 v[212:213], v241 offset:24576
    ds_read_b64_tr_b16 v[214:215], v241 offset:25600
    s_waitcnt lgkmcnt(11)
    v_mfma_f32_32x32x16_bf16 v[0:15], v[224:227], v[84:87], v[0:15]
    ds_read_b64_tr_b16 v[216:217], v242 offset:24576
    ds_read_b64_tr_b16 v[218:219], v242 offset:25600
    s_waitcnt lgkmcnt(11)
    v_mfma_f32_32x32x16_bf16 v[16:31], v[228:231], v[84:87], v[16:31]
    ds_read_b64_tr_b16 v[220:221], v243 offset:24576
    ds_read_b64_tr_b16 v[222:223], v243 offset:25600
    s_waitcnt lgkmcnt(11)
    v_mfma_f32_32x32x16_bf16 v[32:47], v[232:235], v[84:87], v[32:47]
    ds_read_b128 v[92:95], v99 offset:16384
    ds_read_b64_tr_b16 v[224:225], v240 offset:28672
    ds_read_b64_tr_b16 v[226:227], v240 offset:29696
    s_waitcnt lgkmcnt(12)
    v_mfma_f32_32x32x16_bf16 v[48:63], v[236:239], v[84:87], v[48:63]
    ds_read_b64_tr_b16 v[228:229], v241 offset:28672
    ds_read_b64_tr_b16 v[230:231], v241 offset:29696
    s_waitcnt lgkmcnt(11)
    v_mfma_f32_32x32x16_bf16 v[0:15], v[208:211], v[88:91], v[0:15]
    ds_read_b64_tr_b16 v[232:233], v242 offset:28672
    ds_read_b64_tr_b16 v[234:235], v242 offset:29696
    s_waitcnt lgkmcnt(11)
    v_mfma_f32_32x32x16_bf16 v[16:31], v[212:215], v[88:91], v[16:31]
    ds_read_b64_tr_b16 v[236:237], v243 offset:28672
    ds_read_b64_tr_b16 v[238:239], v243 offset:29696
    s_waitcnt lgkmcnt(11)
    v_mfma_f32_32x32x16_bf16 v[32:47], v[216:219], v[88:91], v[32:47]
    s_waitcnt lgkmcnt(9)
    v_mfma_f32_32x32x16_bf16 v[48:63], v[220:223], v[88:91], v[48:63]
    s_waitcnt vmcnt(4) lgkmcnt(0)
    s_barrier
    s_add_u32 m0, s37, 147456
    s_mov_b32 s54, 896
    s_mov_b32 s55, 9088
    buffer_load_dwordx4 v100, s[8:11], s54 offen lds
    buffer_load_dwordx4 v101, s[8:11], s55 offen offset:1024 lds
    s_add_u32 m0, s37, 65536
    s_mov_b32 s54, 4194560
    s_mov_b32 s55, 4226304
    buffer_load_dwordx4 v244, s[12:15], s54 offen lds
    buffer_load_dwordx4 v244, s[12:15], s55 offen offset:1024 lds
    s_add_u32 m0, s37, 16384
    s_nop 0
    buffer_load_dwordx4 v245, s[16:19], s38 offen nt lds
    buffer_load_dwordx4 v246, s[16:19], s38 offen offset:1024 nt lds
    s_add_u32 s38, s38, 16384
    s_and_b32 s38, s38, 0x3ffff
    ds_read_b128 v[64:67], v96 offset:0
    ds_read_b64_tr_b16 v[208:209], v240 offset:32768
    ds_read_b64_tr_b16 v[210:211], v240 offset:33792
    ds_read_b64_tr_b16 v[212:213], v241 offset:32768
    ds_read_b64_tr_b16 v[214:215], v241 offset:33792
    v_mfma_f32_32x32x16_bf16 v[0:15], v[224:227], v[92:95], v[0:15]
    ds_read_b64_tr_b16 v[216:217], v242 offset:32768
    ds_read_b64_tr_b16 v[218:219], v242 offset:33792
    v_mfma_f32_32x32x16_bf16 v[16:31], v[228:231], v[92:95], v[16:31]
    ds_read_b64_tr_b16 v[220:221], v243 offset:32768
    ds_read_b64_tr_b16 v[222:223], v243 offset:33792
    v_mfma_f32_32x32x16_bf16 v[32:47], v[232:235], v[92:95], v[32:47]
    ds_read_b128 v[68:71], v97 offset:0
    ds_read_b64_tr_b16 v[224:225], v240 offset:36864
    ds_read_b64_tr_b16 v[226:227], v240 offset:37888
    v_mfma_f32_32x32x16_bf16 v[48:63], v[236:239], v[92:95], v[48:63]
    ds_read_b64_tr_b16 v[228:229], v241 offset:36864
    ds_read_b64_tr_b16 v[230:231], v241 offset:37888
    s_waitcnt lgkmcnt(11)
    v_mfma_f32_32x32x16_bf16 v[0:15], v[208:211], v[64:67], v[0:15]
    ds_read_b64_tr_b16 v[232:233], v242 offset:36864
    ds_read_b64_tr_b16 v[234:235], v242 offset:37888
    s_waitcnt lgkmcnt(11)
    v_mfma_f32_32x32x16_bf16 v[16:31], v[212:215], v[64:67], v[16:31]
    ds_read_b64_tr_b16 v[236:237], v243 offset:36864
    ds_read_b64_tr_b16 v[238:239], v243 offset:37888
    s_waitcnt lgkmcnt(11)
    v_mfma_f32_32x32x16_bf16 v[32:47], v[216:219], v[64:67], v[32:47]
    ds_read_b128 v[72:75], v98 offset:0
    ds_read_b64_tr_b16 v[208:209], v240 offset:40960
    ds_read_b64_tr_b16 v[210:211], v240 offset:41984
    s_waitcnt lgkmcnt(12)
    v_mfma_f32_32x32x16_bf16 v[48:63], v[220:223], v[64:67], v[48:63]
    ds_read_b64_tr_b16 v[212:213], v241 offset:40960
    ds_read_b64_tr_b16 v[214:215], v241 offset:41984
    s_waitcnt lgkmcnt(11)
    v_mfma_f32_32x32x16_bf16 v[0:15], v[224:227], v[68:71], v[0:15]
    ds_read_b64_tr_b16 v[216:217], v242 offset:40960
    ds_read_b64_tr_b16 v[218:219], v242 offset:41984
    s_waitcnt lgkmcnt(11)
    v_mfma_f32_32x32x16_bf16 v[16:31], v[228:231], v[68:71], v[16:31]
    ds_read_b64_tr_b16 v[220:221], v243 offset:40960
    ds_read_b64_tr_b16 v[222:223], v243 offset:41984
    s_waitcnt lgkmcnt(11)
    v_mfma_f32_32x32x16_bf16 v[32:47], v[232:235], v[68:71], v[32:47]
    ds_read_b128 v[76:79], v99 offset:0
    ds_read_b64_tr_b16 v[224:225], v240 offset:45056
    ds_read_b64_tr_b16 v[226:227], v240 offset:46080
    s_waitcnt lgkmcnt(12)
    v_mfma_f32_32x32x16_bf16 v[48:63], v[236:239], v[68:71], v[48:63]
    ds_read_b64_tr_b16 v[228:229], v241 offset:45056
    ds_read_b64_tr_b16 v[230:231], v241 offset:46080
    s_waitcnt lgkmcnt(11)
    v_mfma_f32_32x32x16_bf16 v[0:15], v[208:211], v[72:75], v[0:15]
    ds_read_b64_tr_b16 v[232:233], v242 offset:45056
    ds_read_b64_tr_b16 v[234:235], v242 offset:46080
    s_waitcnt lgkmcnt(11)
    v_mfma_f32_32x32x16_bf16 v[16:31], v[212:215], v[72:75], v[16:31]
    ds_read_b64_tr_b16 v[236:237], v243 offset:45056
    ds_read_b64_tr_b16 v[238:239], v243 offset:46080
    s_waitcnt lgkmcnt(11)
    v_mfma_f32_32x32x16_bf16 v[32:47], v[216:219], v[72:75], v[32:47]
    s_waitcnt lgkmcnt(9)
    v_mfma_f32_32x32x16_bf16 v[48:63], v[220:223], v[72:75], v[48:63]
    s_waitcnt vmcnt(4) lgkmcnt(0)
    s_barrier
    s_add_u32 m0, s37, 131072
    s_mov_b32 s54, 1024
    s_mov_b32 s55, 9216
    buffer_load_dwordx4 v100, s[8:11], s54 offen lds
    buffer_load_dwordx4 v101, s[8:11], s55 offen offset:1024 lds
    s_add_u32 m0, s37, 81920
    s_nop 0
    buffer_load_dwordx4 v247, s[20:23], s39 offen nt lds
    buffer_load_dwordx4 v247, s[20:23], s39 offen offset:1024 nt lds
    s_add_u32 s39, s39, 16384
    s_and_b32 s39, s39, 0x3ffff
    s_add_u32 m0, s37, 32768
    s_nop 0
    buffer_load_dwordx4 v245, s[16:19], s38 offen nt lds
    buffer_load_dwordx4 v246, s[16:19], s38 offen offset:1024 nt lds
    s_add_u32 s38, s38, 16384
    s_and_b32 s38, s38, 0x3ffff
    ds_read_b128 v[80:83], v96 offset:16384
    ds_read_b64_tr_b16 v[208:209], v240 offset:49152
    ds_read_b64_tr_b16 v[210:211], v240 offset:50176
    ds_read_b64_tr_b16 v[212:213], v241 offset:49152
    ds_read_b64_tr_b16 v[214:215], v241 offset:50176
    v_mfma_f32_32x32x16_bf16 v[0:15], v[224:227], v[76:79], v[0:15]
    ds_read_b64_tr_b16 v[216:217], v242 offset:49152
    ds_read_b64_tr_b16 v[218:219], v242 offset:50176
    v_mfma_f32_32x32x16_bf16 v[16:31], v[228:231], v[76:79], v[16:31]
    ds_read_b64_tr_b16 v[220:221], v243 offset:49152
    ds_read_b64_tr_b16 v[222:223], v243 offset:50176
    v_mfma_f32_32x32x16_bf16 v[32:47], v[232:235], v[76:79], v[32:47]
    ds_read_b128 v[84:87], v97 offset:16384
    ds_read_b64_tr_b16 v[224:225], v240 offset:53248
    ds_read_b64_tr_b16 v[226:227], v240 offset:54272
    v_mfma_f32_32x32x16_bf16 v[48:63], v[236:239], v[76:79], v[48:63]
    ds_read_b64_tr_b16 v[228:229], v241 offset:53248
    ds_read_b64_tr_b16 v[230:231], v241 offset:54272
    s_waitcnt lgkmcnt(11)
    v_mfma_f32_32x32x16_bf16 v[0:15], v[208:211], v[80:83], v[0:15]
    ds_read_b64_tr_b16 v[232:233], v242 offset:53248
    ds_read_b64_tr_b16 v[234:235], v242 offset:54272
    s_waitcnt lgkmcnt(11)
    v_mfma_f32_32x32x16_bf16 v[16:31], v[212:215], v[80:83], v[16:31]
    ds_read_b64_tr_b16 v[236:237], v243 offset:53248
    ds_read_b64_tr_b16 v[238:239], v243 offset:54272
    s_waitcnt lgkmcnt(11)
    v_mfma_f32_32x32x16_bf16 v[32:47], v[216:219], v[80:83], v[32:47]
    ds_read_b128 v[88:91], v98 offset:16384
    ds_read_b64_tr_b16 v[208:209], v240 offset:57344
    ds_read_b64_tr_b16 v[210:211], v240 offset:58368
    s_waitcnt lgkmcnt(12)
    v_mfma_f32_32x32x16_bf16 v[48:63], v[220:223], v[80:83], v[48:63]
    ds_read_b64_tr_b16 v[212:213], v241 offset:57344
    ds_read_b64_tr_b16 v[214:215], v241 offset:58368
    s_waitcnt lgkmcnt(11)
    v_mfma_f32_32x32x16_bf16 v[0:15], v[224:227], v[84:87], v[0:15]
    ds_read_b64_tr_b16 v[216:217], v242 offset:57344
    ds_read_b64_tr_b16 v[218:219], v242 offset:58368
    s_waitcnt lgkmcnt(11)
    v_mfma_f32_32x32x16_bf16 v[16:31], v[228:231], v[84:87], v[16:31]
    ds_read_b64_tr_b16 v[220:221], v243 offset:57344
    ds_read_b64_tr_b16 v[222:223], v243 offset:58368
    s_waitcnt lgkmcnt(11)
    v_mfma_f32_32x32x16_bf16 v[32:47], v[232:235], v[84:87], v[32:47]
    ds_read_b128 v[92:95], v99 offset:16384
    ds_read_b64_tr_b16 v[224:225], v240 offset:61440
    ds_read_b64_tr_b16 v[226:227], v240 offset:62464
    s_waitcnt lgkmcnt(12)
    v_mfma_f32_32x32x16_bf16 v[48:63], v[236:239], v[84:87], v[48:63]
    ds_read_b64_tr_b16 v[228:229], v241 offset:61440
    ds_read_b64_tr_b16 v[230:231], v241 offset:62464
    s_waitcnt lgkmcnt(11)
    v_mfma_f32_32x32x16_bf16 v[0:15], v[208:211], v[88:91], v[0:15]
    ds_read_b64_tr_b16 v[232:233], v242 offset:61440
    ds_read_b64_tr_b16 v[234:235], v242 offset:62464
    s_waitcnt lgkmcnt(11)
    v_mfma_f32_32x32x16_bf16 v[16:31], v[212:215], v[88:91], v[16:31]
    ds_read_b64_tr_b16 v[236:237], v243 offset:61440
    ds_read_b64_tr_b16 v[238:239], v243 offset:62464
    s_waitcnt lgkmcnt(11)
    v_mfma_f32_32x32x16_bf16 v[32:47], v[216:219], v[88:91], v[32:47]
    s_waitcnt lgkmcnt(9)
    v_mfma_f32_32x32x16_bf16 v[48:63], v[220:223], v[88:91], v[48:63]
    s_waitcnt vmcnt(4) lgkmcnt(0)
    s_barrier
    s_add_u32 m0, s37, 98304
    s_nop 0
    buffer_load_dwordx4 v247, s[20:23], s39 offen nt lds
    buffer_load_dwordx4 v247, s[20:23], s39 offen offset:1024 nt lds
    s_add_u32 s39, s39, 16384
    s_and_b32 s39, s39, 0x3ffff
    s_add_u32 m0, s37, 49152
    s_nop 0
    buffer_load_dwordx4 v245, s[16:19], s38 offen nt lds
    buffer_load_dwordx4 v246, s[16:19], s38 offen offset:1024 nt lds
    s_add_u32 s38, s38, 16384
    s_and_b32 s38, s38, 0x3ffff
    ds_read_b128 v[64:67], v96 offset:0
    ds_read_b64_tr_b16 v[208:209], v240 offset:0
    ds_read_b64_tr_b16 v[210:211], v240 offset:1024
    ds_read_b64_tr_b16 v[212:213], v241 offset:0
    ds_read_b64_tr_b16 v[214:215], v241 offset:1024
    v_mfma_f32_32x32x16_bf16 v[0:15], v[224:227], v[92:95], v[0:15]
    ds_read_b64_tr_b16 v[216:217], v242 offset:0
    ds_read_b64_tr_b16 v[218:219], v242 offset:1024
    v_mfma_f32_32x32x16_bf16 v[16:31], v[228:231], v[92:95], v[16:31]
    ds_read_b64_tr_b16 v[220:221], v243 offset:0
    ds_read_b64_tr_b16 v[222:223], v243 offset:1024
    v_mfma_f32_32x32x16_bf16 v[32:47], v[232:235], v[92:95], v[32:47]
    ds_read_b128 v[68:71], v97 offset:0
    ds_read_b64_tr_b16 v[224:225], v240 offset:4096
    ds_read_b64_tr_b16 v[226:227], v240 offset:5120
    v_mfma_f32_32x32x16_bf16 v[48:63], v[236:239], v[92:95], v[48:63]
    ds_read_b64_tr_b16 v[228:229], v241 offset:4096
    ds_read_b64_tr_b16 v[230:231], v241 offset:5120
    s_waitcnt lgkmcnt(11)
    v_mfma_f32_32x32x16_bf16 v[0:15], v[208:211], v[64:67], v[0:15]
    ds_read_b64_tr_b16 v[232:233], v242 offset:4096
    ds_read_b64_tr_b16 v[234:235], v242 offset:5120
    s_waitcnt lgkmcnt(11)
    v_mfma_f32_32x32x16_bf16 v[16:31], v[212:215], v[64:67], v[16:31]
    ds_read_b64_tr_b16 v[236:237], v243 offset:4096
    ds_read_b64_tr_b16 v[238:239], v243 offset:5120
    s_waitcnt lgkmcnt(11)
    v_mfma_f32_32x32x16_bf16 v[32:47], v[216:219], v[64:67], v[32:47]
    ds_read_b128 v[72:75], v98 offset:0
    ds_read_b64_tr_b16 v[208:209], v240 offset:8192
    ds_read_b64_tr_b16 v[210:211], v240 offset:9216
    s_waitcnt lgkmcnt(12)
    v_mfma_f32_32x32x16_bf16 v[48:63], v[220:223], v[64:67], v[48:63]
    ds_read_b64_tr_b16 v[212:213], v241 offset:8192
    ds_read_b64_tr_b16 v[214:215], v241 offset:9216
    s_waitcnt lgkmcnt(11)
    v_mfma_f32_32x32x16_bf16 v[0:15], v[224:227], v[68:71], v[0:15]
    ds_read_b64_tr_b16 v[216:217], v242 offset:8192
    ds_read_b64_tr_b16 v[218:219], v242 offset:9216
    s_waitcnt lgkmcnt(11)
    v_mfma_f32_32x32x16_bf16 v[16:31], v[228:231], v[68:71], v[16:31]
    ds_read_b64_tr_b16 v[220:221], v243 offset:8192
    ds_read_b64_tr_b16 v[222:223], v243 offset:9216
    s_waitcnt lgkmcnt(11)
    v_mfma_f32_32x32x16_bf16 v[32:47], v[232:235], v[68:71], v[32:47]
    ds_read_b128 v[76:79], v99 offset:0
    ds_read_b64_tr_b16 v[224:225], v240 offset:12288
    ds_read_b64_tr_b16 v[226:227], v240 offset:13312
    s_waitcnt lgkmcnt(12)
    v_mfma_f32_32x32x16_bf16 v[48:63], v[236:239], v[68:71], v[48:63]
    ds_read_b64_tr_b16 v[228:229], v241 offset:12288
    ds_read_b64_tr_b16 v[230:231], v241 offset:13312
    s_waitcnt lgkmcnt(11)
    v_mfma_f32_32x32x16_bf16 v[0:15], v[208:211], v[72:75], v[0:15]
    ds_read_b64_tr_b16 v[232:233], v242 offset:12288
    ds_read_b64_tr_b16 v[234:235], v242 offset:13312
    s_waitcnt lgkmcnt(11)
    v_mfma_f32_32x32x16_bf16 v[16:31], v[212:215], v[72:75], v[16:31]
    ds_read_b64_tr_b16 v[236:237], v243 offset:12288
    ds_read_b64_tr_b16 v[238:239], v243 offset:13312
    s_waitcnt lgkmcnt(11)
    v_mfma_f32_32x32x16_bf16 v[32:47], v[216:219], v[72:75], v[32:47]
    s_waitcnt lgkmcnt(9)
    v_mfma_f32_32x32x16_bf16 v[48:63], v[220:223], v[72:75], v[48:63]
    s_waitcnt vmcnt(8) lgkmcnt(0)
    s_barrier
    s_add_u32 m0, s37, 114688
    s_nop 0
    buffer_load_dwordx4 v247, s[20:23], s39 offen nt lds
    buffer_load_dwordx4 v247, s[20:23], s39 offen offset:1024 nt lds
    s_add_u32 s39, s39, 16384
    s_and_b32 s39, s39, 0x3ffff
    s_add_u32 m0, s37, 0
    s_nop 0
    buffer_load_dwordx4 v245, s[16:19], s38 offen nt lds
    buffer_load_dwordx4 v246, s[16:19], s38 offen offset:1024 nt lds
    s_add_u32 s38, s38, 16384
    s_and_b32 s38, s38, 0x3ffff
    v_mfma_f32_32x32x16_bf16 v[0:15], v[224:227], v[76:79], v[0:15]
    v_mfma_f32_32x32x16_bf16 v[16:31], v[228:231], v[76:79], v[16:31]
    v_mfma_f32_32x32x16_bf16 v[32:47], v[232:235], v[76:79], v[32:47]
    v_mfma_f32_32x32x16_bf16 v[48:63], v[236:239], v[76:79], v[48:63]
    s_nop 8
    v_mul_f32 v0, s40, v0
    v_mul_f32 v1, s40, v1
    v_mul_f32 v2, s40, v2
    v_mul_f32 v3, s40, v3
    v_mul_f32 v4, s40, v4
    v_mul_f32 v5, s40, v5
    v_mul_f32 v6, s40, v6
    v_mul_f32 v7, s40, v7
    v_mul_f32 v8, s40, v8
    v_mul_f32 v9, s40, v9
    v_mul_f32 v10, s40, v10
    v_mul_f32 v11, s40, v11
    v_mul_f32 v12, s40, v12
    v_mul_f32 v13, s40, v13
    v_mul_f32 v14, s40, v14
    v_mul_f32 v15, s40, v15
    v_mul_f32 v16, s40, v16
    v_mul_f32 v17, s40, v17
    v_mul_f32 v18, s40, v18
    v_mul_f32 v19, s40, v19
    v_mul_f32 v20, s40, v20
    v_mul_f32 v21, s40, v21
    v_mul_f32 v22, s40, v22
    v_mul_f32 v23, s40, v23
    v_mul_f32 v24, s40, v24
    v_mul_f32 v25, s40, v25
    v_mul_f32 v26, s40, v26
    v_mul_f32 v27, s40, v27
    v_mul_f32 v28, s40, v28
    v_mul_f32 v29, s40, v29
    v_mul_f32 v30, s40, v30
    v_mul_f32 v31, s40, v31
    v_mul_f32 v32, s40, v32
    v_mul_f32 v33, s40, v33
    v_mul_f32 v34, s40, v34
    v_mul_f32 v35, s40, v35
    v_mul_f32 v36, s40, v36
    v_mul_f32 v37, s40, v37
    v_mul_f32 v38, s40, v38
    v_mul_f32 v39, s40, v39
    v_mul_f32 v40, s40, v40
    v_mul_f32 v41, s40, v41
    v_mul_f32 v42, s40, v42
    v_mul_f32 v43, s40, v43
    v_mul_f32 v44, s40, v44
    v_mul_f32 v45, s40, v45
    v_mul_f32 v46, s40, v46
    v_mul_f32 v47, s40, v47
    v_mul_f32 v48, s40, v48
    v_mul_f32 v49, s40, v49
    v_mul_f32 v50, s40, v50
    v_mul_f32 v51, s40, v51
    v_mul_f32 v52, s40, v52
    v_mul_f32 v53, s40, v53
    v_mul_f32 v54, s40, v54
    v_mul_f32 v55, s40, v55
    v_mul_f32 v56, s40, v56
    v_mul_f32 v57, s40, v57
    v_mul_f32 v58, s40, v58
    v_mul_f32 v59, s40, v59
    v_mul_f32 v60, s40, v60
    v_mul_f32 v61, s40, v61
    v_mul_f32 v62, s40, v62
    v_mul_f32 v63, s40, v63
    v_cvt_pk_bf16_f32 v64, v0, v1
    v_cvt_pk_bf16_f32 v65, v2, v3
    v_cvt_pk_bf16_f32 v66, v4, v5
    v_cvt_pk_bf16_f32 v67, v6, v7
    v_cvt_pk_bf16_f32 v68, v8, v9
    v_cvt_pk_bf16_f32 v69, v10, v11
    v_cvt_pk_bf16_f32 v70, v12, v13
    v_cvt_pk_bf16_f32 v71, v14, v15
    v_cvt_pk_bf16_f32 v72, v16, v17
    v_cvt_pk_bf16_f32 v73, v18, v19
    v_cvt_pk_bf16_f32 v74, v20, v21
    v_cvt_pk_bf16_f32 v75, v22, v23
    v_cvt_pk_bf16_f32 v76, v24, v25
    v_cvt_pk_bf16_f32 v77, v26, v27
    v_cvt_pk_bf16_f32 v78, v28, v29
    v_cvt_pk_bf16_f32 v79, v30, v31
    v_cvt_pk_bf16_f32 v80, v32, v33
    v_cvt_pk_bf16_f32 v81, v34, v35
    v_cvt_pk_bf16_f32 v82, v36, v37
    v_cvt_pk_bf16_f32 v83, v38, v39
    v_cvt_pk_bf16_f32 v84, v40, v41
    v_cvt_pk_bf16_f32 v85, v42, v43
    v_cvt_pk_bf16_f32 v86, v44, v45
    v_cvt_pk_bf16_f32 v87, v46, v47
    v_cvt_pk_bf16_f32 v88, v48, v49
    v_cvt_pk_bf16_f32 v89, v50, v51
    v_cvt_pk_bf16_f32 v90, v52, v53
    v_cvt_pk_bf16_f32 v91, v54, v55
    v_cvt_pk_bf16_f32 v92, v56, v57
    v_cvt_pk_bf16_f32 v93, v58, v59
    v_cvt_pk_bf16_f32 v94, v60, v61
    v_cvt_pk_bf16_f32 v95, v62, v63
    v_mov_b32 v254, v245
    v_mov_b32 v228, v244
    v_mov_b32 v229, v100
    v_mov_b32 v253, v101
    s_add_u32 s12, s12, 4096
    s_addc_u32 s13, s13, 0
    s_and_b32 s13, s13, 0xffff
    s_sub_u32 s14, s14, 4096
    s_cmp_lg_u32 s4, 0
    s_cselect_b32 s14, 0, s14
    v_mov_b32 v230, 0
    v_mov_b32 v231, 0
    v_mov_b32 v232, 0
    v_mov_b32 v233, 0
    v_mov_b32 v234, 0
    v_mov_b32 v235, 0
    v_mov_b32 v236, 0
    v_mov_b32 v237, 0
    v_mov_b32 v238, 0
    v_mov_b32 v239, 0
    v_mov_b32 v240, 0
    v_mov_b32 v241, 0
    v_mov_b32 v242, 0
    v_mov_b32 v243, 0
    v_mov_b32 v244, 0
    v_mov_b32 v245, 0
    s_mov_b32 s41, 0xff800000
    s_mov_b32 s49, 0xff7fffff
    v_mov_b32 v0, 0
    v_mov_b32 v1, 0
    v_mov_b32 v2, 0
    v_mov_b32 v3, 0
    v_mov_b32 v4, 0
    v_mov_b32 v5, 0
    v_mov_b32 v6, 0
    v_mov_b32 v7, 0
    v_mov_b32 v8, 0
    v_mov_b32 v9, 0
    v_mov_b32 v10, 0
    v_mov_b32 v11, 0
    v_mov_b32 v12, 0
    v_mov_b32 v13, 0
    v_mov_b32 v14, 0
    v_mov_b32 v15, 0
    v_mov_b32 v16, 0
    v_mov_b32 v17, 0
    v_mov_b32 v18, 0
    v_mov_b32 v19, 0
    v_mov_b32 v20, 0
    v_mov_b32 v21, 0
    v_mov_b32 v22, 0
    v_mov_b32 v23, 0
    v_mov_b32 v24, 0
    v_mov_b32 v25, 0
    v_mov_b32 v26, 0
    v_mov_b32 v27, 0
    v_mov_b32 v28, 0
    v_mov_b32 v29, 0
    v_mov_b32 v30, 0
    v_mov_b32 v31, 0
    v_mov_b32 v32, 0
    v_mov_b32 v33, 0
    v_mov_b32 v34, 0
    v_mov_b32 v35, 0
    v_mov_b32 v36, 0
    v_mov_b32 v37, 0
    v_mov_b32 v38, 0
    v_mov_b32 v39, 0
    v_mov_b32 v40, 0
    v_mov_b32 v41, 0
    v_mov_b32 v42, 0
    v_mov_b32 v43, 0
    v_mov_b32 v44, 0
    v_mov_b32 v45, 0
    v_mov_b32 v46, 0
    v_mov_b32 v47, 0
    v_mov_b32 v48, 0
    v_mov_b32 v49, 0
    v_mov_b32 v50, 0
    v_mov_b32 v51, 0
    v_mov_b32 v52, 0
    v_mov_b32 v53, 0
    v_mov_b32 v54, 0
    v_mov_b32 v55, 0
    v_mov_b32 v56, 0
    v_mov_b32 v57, 0
    v_mov_b32 v58, 0
    v_mov_b32 v59, 0
    v_mov_b32 v60, 0
    v_mov_b32 v61, 0
    v_mov_b32 v62, 0
    v_mov_b32 v63, 0
    v_and_b32 v248, 31, v249
    v_lshrrev_b32 v250, 5, v249
    v_and_b32 v251, 15, v249
    v_xor_b32 v251, v251, v250
    v_lshlrev_b32 v251, 4, v251
    v_lshl_add_u32 v208, v248, 8, v251
    v_xor_b32 v209, 32, v208
    v_xor_b32 v210, 64, v208
    v_xor_b32 v211, 96, v208
    v_xor_b32 v212, 128, v208
    v_xor_b32 v213, 160, v208
    v_xor_b32 v214, 192, v208
    v_xor_b32 v215, 224, v208
    v_bfe_u32 v248, v249, 2, 2
    v_bfe_u32 v251, v249, 4, 1
    v_bfe_u32 v252, v249, 1, 1
    v_lshl_add_u32 v251, v251, 1, v252
    v_lshlrev_b32 v252, 2, v248
    v_xor_b32 v251, v251, v252
    v_lshlrev_b32 v251, 4, v251
    v_and_b32 v252, 1, v249
    v_lshl_add_u32 v251, v252, 3, v251
    v_lshl_add_u32 v252, v250, 2, v248
    v_lshl_add_u32 v251, v252, 8, v251
    v_add_u32 v216, 0x10000, v251
    v_xor_b32 v217, 64, v216
    v_xor_b32 v218, 128, v216
    v_xor_b32 v219, 192, v216
    v_mov_b32 v220, 0xf149f2ca
    v_mov_b32 v222, 0
    v_mov_b32 v221, 0
    v_mov_b32 v160, 0
    v_mov_b32 v161, 0
    v_mov_b32 v162, 0
    v_mov_b32 v163, 0
    v_mov_b32 v164, 0
    v_mov_b32 v165, 0
    v_mov_b32 v166, 0
    v_mov_b32 v167, 0
    v_mov_b32 v168, 0
    v_mov_b32 v169, 0
    v_mov_b32 v170, 0
    v_mov_b32 v171, 0
    v_mov_b32 v172, 0
    v_mov_b32 v173, 0
    v_mov_b32 v174, 0
    v_mov_b32 v175, 0
    v_mov_b32 v176, 0
    v_mov_b32 v177, 0
    v_mov_b32 v178, 0
    v_mov_b32 v179, 0
    v_mov_b32 v180, 0
    v_mov_b32 v181, 0
    v_mov_b32 v182, 0
    v_mov_b32 v183, 0
    v_mov_b32 v184, 0
    v_mov_b32 v185, 0
    v_mov_b32 v186, 0
    v_mov_b32 v187, 0
    v_mov_b32 v188, 0
    v_mov_b32 v189, 0
    v_mov_b32 v190, 0
    v_mov_b32 v191, 0
    v_mov_b32 v192, 0
    v_mov_b32 v193, 0
    v_mov_b32 v194, 0
    v_mov_b32 v195, 0
    v_mov_b32 v196, 0
    v_mov_b32 v197, 0
    v_mov_b32 v198, 0
    v_mov_b32 v199, 0
    v_mov_b32 v200, 0
    v_mov_b32 v201, 0
    v_mov_b32 v202, 0
    v_mov_b32 v203, 0
    v_mov_b32 v204, 0
    v_mov_b32 v205, 0
    v_mov_b32 v206, 0
    v_mov_b32 v207, 0
    ds_read_b128 v[176:179], v208 offset:16384
    ds_read_b128 v[180:183], v209 offset:16384
    ds_read_b128 v[184:187], v210 offset:16384
    ds_read_b128 v[188:191], v211 offset:16384
    ds_read_b128 v[192:195], v212 offset:16384
    ds_read_b128 v[196:199], v213 offset:16384
    s_waitcnt lgkmcnt(5)
    v_mfma_f32_32x32x16_bf16 v[96:111], v[176:179], v[64:67], v[230:245]
    ds_read_b128 v[200:203], v214 offset:16384
    s_waitcnt lgkmcnt(5)
    v_mfma_f32_32x32x16_bf16 v[96:111], v[180:183], v[68:71], v[96:111]
    ds_read_b128 v[204:207], v215 offset:16384
    s_waitcnt lgkmcnt(5)
    v_mfma_f32_32x32x16_bf16 v[96:111], v[184:187], v[72:75], v[96:111]
    ds_read_b128 v[176:179], v208 offset:24576
    s_waitcnt lgkmcnt(5)
    v_mfma_f32_32x32x16_bf16 v[96:111], v[188:191], v[76:79], v[96:111]
    ds_read_b128 v[180:183], v209 offset:24576
    s_waitcnt lgkmcnt(5)
    v_mfma_f32_32x32x16_bf16 v[96:111], v[192:195], v[80:83], v[96:111]
    ds_read_b128 v[184:187], v210 offset:24576
    s_waitcnt lgkmcnt(5)
    v_mfma_f32_32x32x16_bf16 v[96:111], v[196:199], v[84:87], v[96:111]
    ds_read_b128 v[188:191], v211 offset:24576
    s_waitcnt lgkmcnt(5)
    v_mfma_f32_32x32x16_bf16 v[96:111], v[200:203], v[88:91], v[96:111]
    ds_read_b128 v[192:195], v212 offset:24576
    s_waitcnt lgkmcnt(5)
    v_mfma_f32_32x32x16_bf16 v[96:111], v[204:207], v[92:95], v[96:111]
    ds_read_b128 v[196:199], v213 offset:24576
    s_waitcnt lgkmcnt(5)
    v_mfma_f32_32x32x16_bf16 v[112:127], v[176:179], v[64:67], v[230:245]
    ds_read_b128 v[200:203], v214 offset:24576
    s_waitcnt lgkmcnt(5)
    v_mfma_f32_32x32x16_bf16 v[112:127], v[180:183], v[68:71], v[112:127]
    ds_read_b128 v[204:207], v215 offset:24576
    s_waitcnt lgkmcnt(5)
    v_mfma_f32_32x32x16_bf16 v[112:127], v[184:187], v[72:75], v[112:127]
    s_waitcnt lgkmcnt(4)
    v_mfma_f32_32x32x16_bf16 v[112:127], v[188:191], v[76:79], v[112:127]
    s_waitcnt lgkmcnt(3)
    v_mfma_f32_32x32x16_bf16 v[112:127], v[192:195], v[80:83], v[112:127]
    s_waitcnt lgkmcnt(2)
    v_mfma_f32_32x32x16_bf16 v[112:127], v[196:199], v[84:87], v[112:127]
    s_waitcnt lgkmcnt(1)
    v_mfma_f32_32x32x16_bf16 v[112:127], v[200:203], v[88:91], v[112:127]
    s_waitcnt lgkmcnt(0)
    v_mfma_f32_32x32x16_bf16 v[112:127], v[204:207], v[92:95], v[112:127]
    v_max3_f32 v225, v96, v97, v98
    v_max3_f32 v226, v99, v100, v101
    v_max3_f32 v225, v225, v102, v103
    v_max3_f32 v226, v226, v104, v105
    v_max3_f32 v225, v225, v106, v107
    v_max3_f32 v226, v226, v108, v109
    v_max3_f32 v225, v225, v110, v111
    s_nop 4
    v_max3_f32 v226, v226, v112, v113
    v_max3_f32 v225, v225, v114, v115
    v_max3_f32 v226, v226, v116, v117
    v_max3_f32 v225, v225, v118, v119
    v_max3_f32 v226, v226, v120, v121
    v_max3_f32 v225, v225, v122, v123
    v_max3_f32 v226, v226, v124, v125
    v_max3_f32 v225, v225, v126, v127
    v_max_f32 v225, v225, v226
    v_mov_b32 v226, v225
    s_nop 1
    v_permlane32_swap_b32 v225, v226
    v_max_f32 v225, v225, v226
    v_cmp_lt_f32 vcc, s41, v225
    s_cbranch_vccz Ldec1
    v_max_f32 v226, s49, v225
    v_sub_f32 v227, 0, v226
    v_min_f32 v227, 0, v227
    v_exp_f32 v224, v227
    v_sub_f32 v96, v96, v226
    v_sub_f32 v97, v97, v226
    v_sub_f32 v98, v98, v226
    v_sub_f32 v99, v99, v226
    v_sub_f32 v100, v100, v226
    v_sub_f32 v101, v101, v226
    v_sub_f32 v102, v102, v226
    v_sub_f32 v103, v103, v226
    v_sub_f32 v104, v104, v226
    v_sub_f32 v105, v105, v226
    v_sub_f32 v106, v106, v226
    v_sub_f32 v107, v107, v226
    v_sub_f32 v108, v108, v226
    v_sub_f32 v109, v109, v226
    v_sub_f32 v110, v110, v226
    v_sub_f32 v111, v111, v226
    v_sub_f32 v112, v112, v226
    v_sub_f32 v113, v113, v226
    v_sub_f32 v114, v114, v226
    v_sub_f32 v115, v115, v226
    v_sub_f32 v116, v116, v226
    v_sub_f32 v117, v117, v226
    v_sub_f32 v118, v118, v226
    v_sub_f32 v119, v119, v226
    v_sub_f32 v120, v120, v226
    v_sub_f32 v121, v121, v226
    v_sub_f32 v122, v122, v226
    v_sub_f32 v123, v123, v226
    v_sub_f32 v124, v124, v226
    v_sub_f32 v125, v125, v226
    v_sub_f32 v126, v126, v226
    v_sub_f32 v127, v127, v226
    v_sub_f32 v230, v230, v226
    v_sub_f32 v231, v231, v226
    v_sub_f32 v232, v232, v226
    v_sub_f32 v233, v233, v226
    v_sub_f32 v234, v234, v226
    v_sub_f32 v235, v235, v226
    v_sub_f32 v236, v236, v226
    v_sub_f32 v237, v237, v226
    v_sub_f32 v238, v238, v226
    v_sub_f32 v239, v239, v226
    v_sub_f32 v240, v240, v226
    v_sub_f32 v241, v241, v226
    v_sub_f32 v242, v242, v226
    v_sub_f32 v243, v243, v226
    v_sub_f32 v244, v244, v226
    v_sub_f32 v245, v245, v226
    s_mov_b32 s42, 1
    s_mov_b32 s41, 0x41000000
    s_mov_b32 s49, 0
Ldec1:
    v_exp_f32 v96, v96
    v_exp_f32 v97, v97
    v_exp_f32 v98, v98
    v_mov_b32 v223, v96
    v_exp_f32 v99, v99
    v_add_f32 v223, v223, v97
    v_exp_f32 v100, v100
    v_add_f32 v223, v223, v98
    v_exp_f32 v101, v101
    v_add_f32 v223, v223, v99
    v_exp_f32 v102, v102
    v_add_f32 v223, v223, v100
    v_exp_f32 v103, v103
    v_add_f32 v223, v223, v101
    v_exp_f32 v104, v104
    v_add_f32 v223, v223, v102
    v_exp_f32 v105, v105
    v_add_f32 v223, v223, v103
    v_exp_f32 v106, v106
    v_mov_b32 v176, 0
    v_mov_b32 v177, 0
    v_mov_b32 v178, 0
    v_mov_b32 v179, 0
    v_mov_b32 v180, 0
    v_mov_b32 v181, 0
    v_mov_b32 v182, 0
    v_mov_b32 v183, 0
    v_mov_b32 v184, 0
    v_mov_b32 v185, 0
    v_mov_b32 v186, 0
    v_mov_b32 v187, 0
    v_mov_b32 v188, 0
    v_mov_b32 v189, 0
    v_mov_b32 v190, 0
    v_mov_b32 v191, 0
    s_mov_b32 s43, 0
Lmain:
    s_waitcnt vmcnt(8) lgkmcnt(0)
    s_barrier
    s_add_u32 m0, s37, 65536
    s_nop 0
    buffer_load_dwordx4 v247, s[20:23], s39 offen nt lds
    buffer_load_dwordx4 v247, s[20:23], s39 offen offset:1024 nt lds
    s_add_u32 s39, s39, 16384
    s_and_b32 s39, s39, 0x3ffff
    s_add_u32 m0, s37, 16384
    s_nop 0
    buffer_load_dwordx4 v254, s[16:19], s38 offen nt lds
    buffer_load_dwordx4 v246, s[16:19], s38 offen offset:1024 nt lds
    s_add_u32 s38, s38, 16384
    s_and_b32 s38, s38, 0x3ffff
    ds_read_b128 v[192:195], v208 offset:32768
    ds_read_b128 v[196:199], v209 offset:32768
    v_mfma_f32_32x32x16_bf16 v[0:15], v[176:179], v[172:175], v[0:15]
    v_add_f32 v223, v223, v104
    v_exp_f32 v107, v107
    v_add_f32 v223, v223, v105
    ds_read_b128 v[200:203], v210 offset:32768
    v_mfma_f32_32x32x16_bf16 v[16:31], v[180:183], v[172:175], v[16:31]
    v_exp_f32 v108, v108
    v_add_f32 v223, v223, v106
    v_exp_f32 v109, v109
    ds_read_b128 v[204:207], v211 offset:32768
    v_mfma_f32_32x32x16_bf16 v[32:47], v[184:187], v[172:175], v[32:47]
    v_add_f32 v223, v223, v107
    v_exp_f32 v110, v110
    v_add_f32 v223, v223, v108
    v_exp_f32 v111, v111
    ds_read_b128 v[176:179], v212 offset:32768
    v_mfma_f32_32x32x16_bf16 v[48:63], v[188:191], v[172:175], v[48:63]
    v_add_f32 v223, v223, v109
    v_add_f32 v223, v223, v110
    v_add_f32 v223, v223, v111
    ds_read_b128 v[180:183], v213 offset:32768
    s_waitcnt lgkmcnt(5)
    v_mfma_f32_32x32x16_bf16 v[128:143], v[192:195], v[64:67], v[230:245]
    s_cmp_eq_u32 s42, 0
    s_cbranch_scc1 Lrs2
    s_nop 15
    v_mul_f32 v0, v224, v0
    v_mul_f32 v1, v224, v1
    v_mul_f32 v2, v224, v2
    v_mul_f32 v3, v224, v3
    v_mul_f32 v4, v224, v4
    v_mul_f32 v5, v224, v5
    v_mul_f32 v6, v224, v6
    v_mul_f32 v7, v224, v7
    v_mul_f32 v8, v224, v8
    v_mul_f32 v9, v224, v9
    v_mul_f32 v10, v224, v10
    v_mul_f32 v11, v224, v11
    v_mul_f32 v12, v224, v12
    v_mul_f32 v13, v224, v13
    v_mul_f32 v14, v224, v14
    v_mul_f32 v15, v224, v15
    v_mul_f32 v16, v224, v16
    v_mul_f32 v17, v224, v17
    v_mul_f32 v18, v224, v18
    v_mul_f32 v19, v224, v19
    v_mul_f32 v20, v224, v20
    v_mul_f32 v21, v224, v21
    v_mul_f32 v22, v224, v22
    v_mul_f32 v23, v224, v23
    v_mul_f32 v24, v224, v24
    v_mul_f32 v25, v224, v25
    v_mul_f32 v26, v224, v26
    v_mul_f32 v27, v224, v27
    v_mul_f32 v28, v224, v28
    v_mul_f32 v29, v224, v29
    v_mul_f32 v30, v224, v30
    v_mul_f32 v31, v224, v31
    v_mul_f32 v32, v224, v32
    v_mul_f32 v33, v224, v33
    v_mul_f32 v34, v224, v34
    v_mul_f32 v35, v224, v35
    v_mul_f32 v36, v224, v36
    v_mul_f32 v37, v224, v37
    v_mul_f32 v38, v224, v38
    v_mul_f32 v39, v224, v39
    v_mul_f32 v40, v224, v40
    v_mul_f32 v41, v224, v41
    v_mul_f32 v42, v224, v42
    v_mul_f32 v43, v224, v43
    v_mul_f32 v44, v224, v44
    v_mul_f32 v45, v224, v45
    v_mul_f32 v46, v224, v46
    v_mul_f32 v47, v224, v47
    v_mul_f32 v48, v224, v48
    v_mul_f32 v49, v224, v49
    v_mul_f32 v50, v224, v50
    v_mul_f32 v51, v224, v51
    v_mul_f32 v52, v224, v52
    v_mul_f32 v53, v224, v53
    v_mul_f32 v54, v224, v54
    v_mul_f32 v55, v224, v55
    v_mul_f32 v56, v224, v56
    v_mul_f32 v57, v224, v57
    v_mul_f32 v58, v224, v58
    v_mul_f32 v59, v224, v59
    v_mul_f32 v60, v224, v60
    v_mul_f32 v61, v224, v61
    v_mul_f32 v62, v224, v62
    v_mul_f32 v63, v224, v63
    v_mul_f32 v222, v224, v222
    s_mov_b32 s42, 0
    s_nop 1
Lrs2:
    v_cvt_pk_bf16_f32 v160, v96, v97
    v_cvt_pk_bf16_f32 v161, v98, v99
    v_cvt_pk_bf16_f32 v162, v100, v101
    ds_read_b128 v[184:187], v214 offset:32768
    s_waitcnt lgkmcnt(5)
    v_mfma_f32_32x32x16_bf16 v[128:143], v[196:199], v[68:71], v[128:143]
    v_cvt_pk_bf16_f32 v163, v102, v103
    v_cvt_pk_bf16_f32 v164, v104, v105
    v_cvt_pk_bf16_f32 v165, v106, v107
    v_cvt_pk_bf16_f32 v166, v108, v109
    ds_read_b128 v[188:191], v215 offset:32768
    s_waitcnt lgkmcnt(5)
    v_mfma_f32_32x32x16_bf16 v[128:143], v[200:203], v[72:75], v[128:143]
    v_cvt_pk_bf16_f32 v167, v110, v111
    v_exp_f32 v112, v112
    v_exp_f32 v113, v113
    ds_read_b128 v[192:195], v208 offset:40960
    s_waitcnt lgkmcnt(5)
    v_mfma_f32_32x32x16_bf16 v[128:143], v[204:207], v[76:79], v[128:143]
    v_exp_f32 v114, v114
    v_add_f32 v223, v223, v112
    v_exp_f32 v115, v115
    ds_read_b128 v[196:199], v209 offset:40960
    s_waitcnt lgkmcnt(5)
    v_mfma_f32_32x32x16_bf16 v[128:143], v[176:179], v[80:83], v[128:143]
    v_add_f32 v223, v223, v113
    v_exp_f32 v116, v116
    v_add_f32 v223, v223, v114
    ds_read_b128 v[200:203], v210 offset:40960
    s_waitcnt lgkmcnt(5)
    v_mfma_f32_32x32x16_bf16 v[128:143], v[180:183], v[84:87], v[128:143]
    v_exp_f32 v117, v117
    v_add_f32 v223, v223, v115
    v_exp_f32 v118, v118
    v_add_f32 v223, v223, v116
    ds_read_b128 v[204:207], v211 offset:40960
    s_waitcnt lgkmcnt(5)
    v_mfma_f32_32x32x16_bf16 v[128:143], v[184:187], v[88:91], v[128:143]
    v_exp_f32 v119, v119
    v_add_f32 v223, v223, v117
    v_exp_f32 v120, v120
    ds_read_b128 v[176:179], v212 offset:40960
    s_waitcnt lgkmcnt(5)
    v_mfma_f32_32x32x16_bf16 v[128:143], v[188:191], v[92:95], v[128:143]
    v_add_f32 v223, v223, v118
    v_exp_f32 v121, v121
    v_add_f32 v223, v223, v119
    ds_read_b128 v[180:183], v213 offset:40960
    s_waitcnt lgkmcnt(5)
    v_mfma_f32_32x32x16_bf16 v[144:159], v[192:195], v[64:67], v[230:245]
    v_exp_f32 v122, v122
    v_add_f32 v223, v223, v120
    v_exp_f32 v123, v123
    ds_read_b128 v[184:187], v214 offset:40960
    s_waitcnt lgkmcnt(5)
    v_mfma_f32_32x32x16_bf16 v[144:159], v[196:199], v[68:71], v[144:159]
    v_add_f32 v223, v223, v121
    v_exp_f32 v124, v124
    v_add_f32 v223, v223, v122
    v_exp_f32 v125, v125
    ds_read_b128 v[188:191], v215 offset:40960
    s_waitcnt lgkmcnt(5)
    v_mfma_f32_32x32x16_bf16 v[144:159], v[200:203], v[72:75], v[144:159]
    v_add_f32 v223, v223, v123
    v_exp_f32 v126, v126
    v_add_f32 v223, v223, v124
    ds_read_b64_tr_b16 v[192:193], v216 offset:16384
    ds_read_b64_tr_b16 v[194:195], v216 offset:18432
    s_waitcnt lgkmcnt(6)
    v_mfma_f32_32x32x16_bf16 v[144:159], v[204:207], v[76:79], v[144:159]
    v_exp_f32 v127, v127
    v_add_f32 v223, v223, v125
    v_add_f32 v223, v223, v126
    ds_read_b64_tr_b16 v[196:197], v217 offset:16384
    ds_read_b64_tr_b16 v[198:199], v217 offset:18432
    s_waitcnt lgkmcnt(7)
    v_mfma_f32_32x32x16_bf16 v[144:159], v[176:179], v[80:83], v[144:159]
    v_add_f32 v223, v223, v127
    v_cvt_pk_bf16_f32 v168, v112, v113
    v_cvt_pk_bf16_f32 v169, v114, v115
    ds_read_b64_tr_b16 v[200:201], v218 offset:16384
    ds_read_b64_tr_b16 v[202:203], v218 offset:18432
    s_waitcnt lgkmcnt(8)
    v_mfma_f32_32x32x16_bf16 v[144:159], v[180:183], v[84:87], v[144:159]
    v_cvt_pk_bf16_f32 v170, v116, v117
    v_cvt_pk_bf16_f32 v171, v118, v119
    v_cvt_pk_bf16_f32 v172, v120, v121
    v_cvt_pk_bf16_f32 v173, v122, v123
    ds_read_b64_tr_b16 v[204:205], v219 offset:16384
    ds_read_b64_tr_b16 v[206:207], v219 offset:18432
    s_waitcnt lgkmcnt(9)
    v_mfma_f32_32x32x16_bf16 v[144:159], v[184:187], v[88:91], v[144:159]
    v_cvt_pk_bf16_f32 v174, v124, v125
    v_cvt_pk_bf16_f32 v175, v126, v127
    v_add_f32 v222, v222, v223
    ds_read_b64_tr_b16 v[176:177], v216 offset:20480
    ds_read_b64_tr_b16 v[178:179], v216 offset:22528
    s_waitcnt lgkmcnt(10)
    v_mfma_f32_32x32x16_bf16 v[144:159], v[188:191], v[92:95], v[144:159]
    ds_read_b64_tr_b16 v[180:181], v217 offset:20480
    ds_read_b64_tr_b16 v[182:183], v217 offset:22528
    s_waitcnt lgkmcnt(10)
    v_mfma_f32_32x32x16_bf16 v[0:15], v[192:195], v[160:163], v[0:15]
    v_max3_f32 v225, v128, v129, v130
    v_max3_f32 v226, v131, v132, v133
    v_max3_f32 v225, v225, v134, v135
    ds_read_b64_tr_b16 v[184:185], v218 offset:20480
    ds_read_b64_tr_b16 v[186:187], v218 offset:22528
    s_waitcnt lgkmcnt(10)
    v_mfma_f32_32x32x16_bf16 v[16:31], v[196:199], v[160:163], v[16:31]
    v_max3_f32 v226, v226, v136, v137
    v_max3_f32 v225, v225, v138, v139
    v_max3_f32 v226, v226, v140, v141
    ds_read_b64_tr_b16 v[188:189], v219 offset:20480
    ds_read_b64_tr_b16 v[190:191], v219 offset:22528
    s_waitcnt lgkmcnt(10)
    v_mfma_f32_32x32x16_bf16 v[32:47], v[200:203], v[160:163], v[32:47]
    v_max3_f32 v225, v225, v142, v143
    v_max3_f32 v226, v226, v144, v145
    v_max3_f32 v225, v225, v146, v147
    v_max3_f32 v226, v226, v148, v149
    ds_read_b64_tr_b16 v[192:193], v216 offset:24576
    ds_read_b64_tr_b16 v[194:195], v216 offset:26624
    s_waitcnt lgkmcnt(10)
    v_mfma_f32_32x32x16_bf16 v[48:63], v[204:207], v[160:163], v[48:63]
    v_max3_f32 v225, v225, v150, v151
    v_max3_f32 v226, v226, v152, v153
    v_max3_f32 v225, v225, v154, v155
    ds_read_b64_tr_b16 v[196:197], v217 offset:24576
    ds_read_b64_tr_b16 v[198:199], v217 offset:26624
    s_waitcnt lgkmcnt(10)
    v_mfma_f32_32x32x16_bf16 v[0:15], v[176:179], v[164:167], v[0:15]
    v_max3_f32 v226, v226, v156, v157
    v_max3_f32 v225, v225, v158, v159
    v_max_f32 v225, v225, v226
    ds_read_b64_tr_b16 v[200:201], v218 offset:24576
    ds_read_b64_tr_b16 v[202:203], v218 offset:26624
    s_waitcnt lgkmcnt(10)
    v_mfma_f32_32x32x16_bf16 v[16:31], v[180:183], v[164:167], v[16:31]
    v_mov_b32 v226, v225
    s_nop 1
    v_permlane32_swap_b32 v225, v226
    v_max_f32 v225, v225, v226
    v_cmp_lt_f32 vcc, s41, v225
    s_cbranch_vccz Ldec3
    v_max_f32 v226, s49, v225
    v_sub_f32 v227, 0, v226
    v_min_f32 v227, 0, v227
    v_exp_f32 v224, v227
    v_sub_f32 v128, v128, v226
    v_sub_f32 v129, v129, v226
    v_sub_f32 v130, v130, v226
    v_sub_f32 v131, v131, v226
    v_sub_f32 v132, v132, v226
    v_sub_f32 v133, v133, v226
    v_sub_f32 v134, v134, v226
    v_sub_f32 v135, v135, v226
    v_sub_f32 v136, v136, v226
    v_sub_f32 v137, v137, v226
    v_sub_f32 v138, v138, v226
    v_sub_f32 v139, v139, v226
    v_sub_f32 v140, v140, v226
    v_sub_f32 v141, v141, v226
    v_sub_f32 v142, v142, v226
    v_sub_f32 v143, v143, v226
    v_sub_f32 v144, v144, v226
    v_sub_f32 v145, v145, v226
    v_sub_f32 v146, v146, v226
    v_sub_f32 v147, v147, v226
    v_sub_f32 v148, v148, v226
    v_sub_f32 v149, v149, v226
    v_sub_f32 v150, v150, v226
    v_sub_f32 v151, v151, v226
    v_sub_f32 v152, v152, v226
    v_sub_f32 v153, v153, v226
    v_sub_f32 v154, v154, v226
    v_sub_f32 v155, v155, v226
    v_sub_f32 v156, v156, v226
    v_sub_f32 v157, v157, v226
    v_sub_f32 v158, v158, v226
    v_sub_f32 v159, v159, v226
    v_sub_f32 v230, v230, v226
    v_sub_f32 v231, v231, v226
    v_sub_f32 v232, v232, v226
    v_sub_f32 v233, v233, v226
    v_sub_f32 v234, v234, v226
    v_sub_f32 v235, v235, v226
    v_sub_f32 v236, v236, v226
    v_sub_f32 v237, v237, v226
    v_sub_f32 v238, v238, v226
    v_sub_f32 v239, v239, v226
    v_sub_f32 v240, v240, v226
    v_sub_f32 v241, v241, v226
    v_sub_f32 v242, v242, v226
    v_sub_f32 v243, v243, v226
    v_sub_f32 v244, v244, v226
    v_sub_f32 v245, v245, v226
    s_mov_b32 s42, 1
    s_mov_b32 s41, 0x41000000
    s_mov_b32 s49, 0
Ldec3:
    ds_read_b64_tr_b16 v[204:205], v219 offset:24576
    ds_read_b64_tr_b16 v[206:207], v219 offset:26624
    s_waitcnt lgkmcnt(10)
    v_mfma_f32_32x32x16_bf16 v[32:47], v[184:187], v[164:167], v[32:47]
    v_exp_f32 v128, v128
    v_exp_f32 v129, v129
    v_exp_f32 v130, v130
    ds_read_b64_tr_b16 v[176:177], v216 offset:28672
    ds_read_b64_tr_b16 v[178:179], v216 offset:30720
    s_waitcnt lgkmcnt(10)
    v_mfma_f32_32x32x16_bf16 v[48:63], v[188:191], v[164:167], v[48:63]
    v_mov_b32 v223, v128
    v_exp_f32 v131, v131
    v_add_f32 v223, v223, v129
    ds_read_b64_tr_b16 v[180:181], v217 offset:28672
    ds_read_b64_tr_b16 v[182:183], v217 offset:30720
    s_waitcnt lgkmcnt(10)
    v_mfma_f32_32x32x16_bf16 v[0:15], v[192:195], v[168:171], v[0:15]
    v_exp_f32 v132, v132
    v_add_f32 v223, v223, v130
    v_exp_f32 v133, v133
    ds_read_b64_tr_b16 v[184:185], v218 offset:28672
    ds_read_b64_tr_b16 v[186:187], v218 offset:30720
    s_waitcnt lgkmcnt(10)
    v_mfma_f32_32x32x16_bf16 v[16:31], v[196:199], v[168:171], v[16:31]
    v_add_f32 v223, v223, v131
    v_exp_f32 v134, v134
    v_add_f32 v223, v223, v132
    ds_read_b64_tr_b16 v[188:189], v219 offset:28672
    ds_read_b64_tr_b16 v[190:191], v219 offset:30720
    s_waitcnt lgkmcnt(10)
    v_mfma_f32_32x32x16_bf16 v[32:47], v[200:203], v[168:171], v[32:47]
    v_exp_f32 v135, v135
    v_add_f32 v223, v223, v133
    v_exp_f32 v136, v136
    v_add_f32 v223, v223, v134
    s_waitcnt lgkmcnt(8)
    v_mfma_f32_32x32x16_bf16 v[48:63], v[204:207], v[168:171], v[48:63]
    v_exp_f32 v137, v137
    v_add_f32 v223, v223, v135
    v_exp_f32 v138, v138
    s_waitcnt vmcnt(8) lgkmcnt(0)
    s_barrier
    s_add_u32 m0, s37, 81920
    s_nop 0
    buffer_load_dwordx4 v247, s[20:23], s39 offen nt lds
    buffer_load_dwordx4 v247, s[20:23], s39 offen offset:1024 nt lds
    s_add_u32 s39, s39, 16384
    s_and_b32 s39, s39, 0x3ffff
    s_add_u32 m0, s37, 32768
    s_nop 0
    buffer_load_dwordx4 v254, s[16:19], s38 offen nt lds
    buffer_load_dwordx4 v246, s[16:19], s38 offen offset:1024 nt lds
    s_add_u32 s38, s38, 16384
    s_and_b32 s38, s38, 0x3ffff
    ds_read_b128 v[192:195], v208 offset:49152
    ds_read_b128 v[196:199], v209 offset:49152
    v_mfma_f32_32x32x16_bf16 v[0:15], v[176:179], v[172:175], v[0:15]
    v_add_f32 v223, v223, v136
    v_exp_f32 v139, v139
    v_add_f32 v223, v223, v137
    ds_read_b128 v[200:203], v210 offset:49152
    v_mfma_f32_32x32x16_bf16 v[16:31], v[180:183], v[172:175], v[16:31]
    v_exp_f32 v140, v140
    v_add_f32 v223, v223, v138
    v_exp_f32 v141, v141
    ds_read_b128 v[204:207], v211 offset:49152
    v_mfma_f32_32x32x16_bf16 v[32:47], v[184:187], v[172:175], v[32:47]
    v_add_f32 v223, v223, v139
    v_exp_f32 v142, v142
    v_add_f32 v223, v223, v140
    v_exp_f32 v143, v143
    ds_read_b128 v[176:179], v212 offset:49152
    v_mfma_f32_32x32x16_bf16 v[48:63], v[188:191], v[172:175], v[48:63]
    v_add_f32 v223, v223, v141
    v_add_f32 v223, v223, v142
    v_add_f32 v223, v223, v143
    ds_read_b128 v[180:183], v213 offset:49152
    s_waitcnt lgkmcnt(5)
    v_mfma_f32_32x32x16_bf16 v[96:111], v[192:195], v[64:67], v[230:245]
    s_cmp_eq_u32 s42, 0
    s_cbranch_scc1 Lrs4
    s_nop 15
    v_mul_f32 v0, v224, v0
    v_mul_f32 v1, v224, v1
    v_mul_f32 v2, v224, v2
    v_mul_f32 v3, v224, v3
    v_mul_f32 v4, v224, v4
    v_mul_f32 v5, v224, v5
    v_mul_f32 v6, v224, v6
    v_mul_f32 v7, v224, v7
    v_mul_f32 v8, v224, v8
    v_mul_f32 v9, v224, v9
    v_mul_f32 v10, v224, v10
    v_mul_f32 v11, v224, v11
    v_mul_f32 v12, v224, v12
    v_mul_f32 v13, v224, v13
    v_mul_f32 v14, v224, v14
    v_mul_f32 v15, v224, v15
    v_mul_f32 v16, v224, v16
    v_mul_f32 v17, v224, v17
    v_mul_f32 v18, v224, v18
    v_mul_f32 v19, v224, v19
    v_mul_f32 v20, v224, v20
    v_mul_f32 v21, v224, v21
    v_mul_f32 v22, v224, v22
    v_mul_f32 v23, v224, v23
    v_mul_f32 v24, v224, v24
    v_mul_f32 v25, v224, v25
    v_mul_f32 v26, v224, v26
    v_mul_f32 v27, v224, v27
    v_mul_f32 v28, v224, v28
    v_mul_f32 v29, v224, v29
    v_mul_f32 v30, v224, v30
    v_mul_f32 v31, v224, v31
    v_mul_f32 v32, v224, v32
    v_mul_f32 v33, v224, v33
    v_mul_f32 v34, v224, v34
    v_mul_f32 v35, v224, v35
    v_mul_f32 v36, v224, v36
    v_mul_f32 v37, v224, v37
    v_mul_f32 v38, v224, v38
    v_mul_f32 v39, v224, v39
    v_mul_f32 v40, v224, v40
    v_mul_f32 v41, v224, v41
    v_mul_f32 v42, v224, v42
    v_mul_f32 v43, v224, v43
    v_mul_f32 v44, v224, v44
    v_mul_f32 v45, v224, v45
    v_mul_f32 v46, v224, v46
    v_mul_f32 v47, v224, v47
    v_mul_f32 v48, v224, v48
    v_mul_f32 v49, v224, v49
    v_mul_f32 v50, v224, v50
    v_mul_f32 v51, v224, v51
    v_mul_f32 v52, v224, v52
    v_mul_f32 v53, v224, v53
    v_mul_f32 v54, v224, v54
    v_mul_f32 v55, v224, v55
    v_mul_f32 v56, v224, v56
    v_mul_f32 v57, v224, v57
    v_mul_f32 v58, v224, v58
    v_mul_f32 v59, v224, v59
    v_mul_f32 v60, v224, v60
    v_mul_f32 v61, v224, v61
    v_mul_f32 v62, v224, v62
    v_mul_f32 v63, v224, v63
    v_mul_f32 v222, v224, v222
    s_mov_b32 s42, 0
    s_nop 1
Lrs4:
    v_cvt_pk_bf16_f32 v160, v128, v129
    v_cvt_pk_bf16_f32 v161, v130, v131
    v_cvt_pk_bf16_f32 v162, v132, v133
    ds_read_b128 v[184:187], v214 offset:49152
    s_waitcnt lgkmcnt(5)
    v_mfma_f32_32x32x16_bf16 v[96:111], v[196:199], v[68:71], v[96:111]
    v_cvt_pk_bf16_f32 v163, v134, v135
    v_cvt_pk_bf16_f32 v164, v136, v137
    v_cvt_pk_bf16_f32 v165, v138, v139
    v_cvt_pk_bf16_f32 v166, v140, v141
    ds_read_b128 v[188:191], v215 offset:49152
    s_waitcnt lgkmcnt(5)
    v_mfma_f32_32x32x16_bf16 v[96:111], v[200:203], v[72:75], v[96:111]
    v_cvt_pk_bf16_f32 v167, v142, v143
    v_exp_f32 v144, v144
    v_exp_f32 v145, v145
    ds_read_b128 v[192:195], v208 offset:57344
    s_waitcnt lgkmcnt(5)
    v_mfma_f32_32x32x16_bf16 v[96:111], v[204:207], v[76:79], v[96:111]
    v_exp_f32 v146, v146
    v_add_f32 v223, v223, v144
    v_exp_f32 v147, v147
    ds_read_b128 v[196:199], v209 offset:57344
    s_waitcnt lgkmcnt(5)
    v_mfma_f32_32x32x16_bf16 v[96:111], v[176:179], v[80:83], v[96:111]
    v_add_f32 v223, v223, v145
    v_exp_f32 v148, v148
    v_add_f32 v223, v223, v146
    ds_read_b128 v[200:203], v210 offset:57344
    s_waitcnt lgkmcnt(5)
    v_mfma_f32_32x32x16_bf16 v[96:111], v[180:183], v[84:87], v[96:111]
    v_exp_f32 v149, v149
    v_add_f32 v223, v223, v147
    v_exp_f32 v150, v150
    v_add_f32 v223, v223, v148
    ds_read_b128 v[204:207], v211 offset:57344
    s_waitcnt lgkmcnt(5)
    v_mfma_f32_32x32x16_bf16 v[96:111], v[184:187], v[88:91], v[96:111]
    v_exp_f32 v151, v151
    v_add_f32 v223, v223, v149
    v_exp_f32 v152, v152
    ds_read_b128 v[176:179], v212 offset:57344
    s_waitcnt lgkmcnt(5)
    v_mfma_f32_32x32x16_bf16 v[96:111], v[188:191], v[92:95], v[96:111]
    v_add_f32 v223, v223, v150
    v_exp_f32 v153, v153
    v_add_f32 v223, v223, v151
    ds_read_b128 v[180:183], v213 offset:57344
    s_waitcnt lgkmcnt(5)
    v_mfma_f32_32x32x16_bf16 v[112:127], v[192:195], v[64:67], v[230:245]
    v_exp_f32 v154, v154
    v_add_f32 v223, v223, v152
    v_exp_f32 v155, v155
    ds_read_b128 v[184:187], v214 offset:57344
    s_waitcnt lgkmcnt(5)
    v_mfma_f32_32x32x16_bf16 v[112:127], v[196:199], v[68:71], v[112:127]
    v_add_f32 v223, v223, v153
    v_exp_f32 v156, v156
    v_add_f32 v223, v223, v154
    v_exp_f32 v157, v157
    ds_read_b128 v[188:191], v215 offset:57344
    s_waitcnt lgkmcnt(5)
    v_mfma_f32_32x32x16_bf16 v[112:127], v[200:203], v[72:75], v[112:127]
    v_add_f32 v223, v223, v155
    v_exp_f32 v158, v158
    v_add_f32 v223, v223, v156
    ds_read_b64_tr_b16 v[192:193], v216 offset:32768
    ds_read_b64_tr_b16 v[194:195], v216 offset:34816
    s_waitcnt lgkmcnt(6)
    v_mfma_f32_32x32x16_bf16 v[112:127], v[204:207], v[76:79], v[112:127]
    v_exp_f32 v159, v159
    v_add_f32 v223, v223, v157
    v_add_f32 v223, v223, v158
    ds_read_b64_tr_b16 v[196:197], v217 offset:32768
    ds_read_b64_tr_b16 v[198:199], v217 offset:34816
    s_waitcnt lgkmcnt(7)
    v_mfma_f32_32x32x16_bf16 v[112:127], v[176:179], v[80:83], v[112:127]
    v_add_f32 v223, v223, v159
    v_cvt_pk_bf16_f32 v168, v144, v145
    v_cvt_pk_bf16_f32 v169, v146, v147
    ds_read_b64_tr_b16 v[200:201], v218 offset:32768
    ds_read_b64_tr_b16 v[202:203], v218 offset:34816
    s_waitcnt lgkmcnt(8)
    v_mfma_f32_32x32x16_bf16 v[112:127], v[180:183], v[84:87], v[112:127]
    v_cvt_pk_bf16_f32 v170, v148, v149
    v_cvt_pk_bf16_f32 v171, v150, v151
    v_cvt_pk_bf16_f32 v172, v152, v153
    v_cvt_pk_bf16_f32 v173, v154, v155
    ds_read_b64_tr_b16 v[204:205], v219 offset:32768
    ds_read_b64_tr_b16 v[206:207], v219 offset:34816
    s_waitcnt lgkmcnt(9)
    v_mfma_f32_32x32x16_bf16 v[112:127], v[184:187], v[88:91], v[112:127]
    v_cvt_pk_bf16_f32 v174, v156, v157
    v_cvt_pk_bf16_f32 v175, v158, v159
    v_add_f32 v222, v222, v223
    ds_read_b64_tr_b16 v[176:177], v216 offset:36864
    ds_read_b64_tr_b16 v[178:179], v216 offset:38912
    s_waitcnt lgkmcnt(10)
    v_mfma_f32_32x32x16_bf16 v[112:127], v[188:191], v[92:95], v[112:127]
    ds_read_b64_tr_b16 v[180:181], v217 offset:36864
    ds_read_b64_tr_b16 v[182:183], v217 offset:38912
    s_waitcnt lgkmcnt(10)
    v_mfma_f32_32x32x16_bf16 v[0:15], v[192:195], v[160:163], v[0:15]
    v_max3_f32 v225, v96, v97, v98
    v_max3_f32 v226, v99, v100, v101
    v_max3_f32 v225, v225, v102, v103
    ds_read_b64_tr_b16 v[184:185], v218 offset:36864
    ds_read_b64_tr_b16 v[186:187], v218 offset:38912
    s_waitcnt lgkmcnt(10)
    v_mfma_f32_32x32x16_bf16 v[16:31], v[196:199], v[160:163], v[16:31]
    v_max3_f32 v226, v226, v104, v105
    v_max3_f32 v225, v225, v106, v107
    v_max3_f32 v226, v226, v108, v109
    ds_read_b64_tr_b16 v[188:189], v219 offset:36864
    ds_read_b64_tr_b16 v[190:191], v219 offset:38912
    s_waitcnt lgkmcnt(10)
    v_mfma_f32_32x32x16_bf16 v[32:47], v[200:203], v[160:163], v[32:47]
    v_max3_f32 v225, v225, v110, v111
    v_max3_f32 v226, v226, v112, v113
    v_max3_f32 v225, v225, v114, v115
    v_max3_f32 v226, v226, v116, v117
    ds_read_b64_tr_b16 v[192:193], v216 offset:40960
    ds_read_b64_tr_b16 v[194:195], v216 offset:43008
    s_waitcnt lgkmcnt(10)
    v_mfma_f32_32x32x16_bf16 v[48:63], v[204:207], v[160:163], v[48:63]
    v_max3_f32 v225, v225, v118, v119
    v_max3_f32 v226, v226, v120, v121
    v_max3_f32 v225, v225, v122, v123
    ds_read_b64_tr_b16 v[196:197], v217 offset:40960
    ds_read_b64_tr_b16 v[198:199], v217 offset:43008
    s_waitcnt lgkmcnt(10)
    v_mfma_f32_32x32x16_bf16 v[0:15], v[176:179], v[164:167], v[0:15]
    v_max3_f32 v226, v226, v124, v125
    v_max3_f32 v225, v225, v126, v127
    v_max_f32 v225, v225, v226
    ds_read_b64_tr_b16 v[200:201], v218 offset:40960
    ds_read_b64_tr_b16 v[202:203], v218 offset:43008
    s_waitcnt lgkmcnt(10)
    v_mfma_f32_32x32x16_bf16 v[16:31], v[180:183], v[164:167], v[16:31]
    v_mov_b32 v226, v225
    s_nop 1
    v_permlane32_swap_b32 v225, v226
    v_max_f32 v225, v225, v226
    v_cmp_lt_f32 vcc, s41, v225
    s_cbranch_vccz Ldec5
    v_max_f32 v226, s49, v225
    v_sub_f32 v227, 0, v226
    v_min_f32 v227, 0, v227
    v_exp_f32 v224, v227
    v_sub_f32 v96, v96, v226
    v_sub_f32 v97, v97, v226
    v_sub_f32 v98, v98, v226
    v_sub_f32 v99, v99, v226
    v_sub_f32 v100, v100, v226
    v_sub_f32 v101, v101, v226
    v_sub_f32 v102, v102, v226
    v_sub_f32 v103, v103, v226
    v_sub_f32 v104, v104, v226
    v_sub_f32 v105, v105, v226
    v_sub_f32 v106, v106, v226
    v_sub_f32 v107, v107, v226
    v_sub_f32 v108, v108, v226
    v_sub_f32 v109, v109, v226
    v_sub_f32 v110, v110, v226
    v_sub_f32 v111, v111, v226
    v_sub_f32 v112, v112, v226
    v_sub_f32 v113, v113, v226
    v_sub_f32 v114, v114, v226
    v_sub_f32 v115, v115, v226
    v_sub_f32 v116, v116, v226
    v_sub_f32 v117, v117, v226
    v_sub_f32 v118, v118, v226
    v_sub_f32 v119, v119, v226
    v_sub_f32 v120, v120, v226
    v_sub_f32 v121, v121, v226
    v_sub_f32 v122, v122, v226
    v_sub_f32 v123, v123, v226
    v_sub_f32 v124, v124, v226
    v_sub_f32 v125, v125, v226
    v_sub_f32 v126, v126, v226
    v_sub_f32 v127, v127, v226
    v_sub_f32 v230, v230, v226
    v_sub_f32 v231, v231, v226
    v_sub_f32 v232, v232, v226
    v_sub_f32 v233, v233, v226
    v_sub_f32 v234, v234, v226
    v_sub_f32 v235, v235, v226
    v_sub_f32 v236, v236, v226
    v_sub_f32 v237, v237, v226
    v_sub_f32 v238, v238, v226
    v_sub_f32 v239, v239, v226
    v_sub_f32 v240, v240, v226
    v_sub_f32 v241, v241, v226
    v_sub_f32 v242, v242, v226
    v_sub_f32 v243, v243, v226
    v_sub_f32 v244, v244, v226
    v_sub_f32 v245, v245, v226
    s_mov_b32 s42, 1
    s_mov_b32 s41, 0x41000000
    s_mov_b32 s49, 0
Ldec5:
    ds_read_b64_tr_b16 v[204:205], v219 offset:40960
    ds_read_b64_tr_b16 v[206:207], v219 offset:43008
    s_waitcnt lgkmcnt(10)
    v_mfma_f32_32x32x16_bf16 v[32:47], v[184:187], v[164:167], v[32:47]
    v_exp_f32 v96, v96
    v_exp_f32 v97, v97
    v_exp_f32 v98, v98
    ds_read_b64_tr_b16 v[176:177], v216 offset:45056
    ds_read_b64_tr_b16 v[178:179], v216 offset:47104
    s_waitcnt lgkmcnt(10)
    v_mfma_f32_32x32x16_bf16 v[48:63], v[188:191], v[164:167], v[48:63]
    v_mov_b32 v223, v96
    v_exp_f32 v99, v99
    v_add_f32 v223, v223, v97
    ds_read_b64_tr_b16 v[180:181], v217 offset:45056
    ds_read_b64_tr_b16 v[182:183], v217 offset:47104
    s_waitcnt lgkmcnt(10)
    v_mfma_f32_32x32x16_bf16 v[0:15], v[192:195], v[168:171], v[0:15]
    v_exp_f32 v100, v100
    v_add_f32 v223, v223, v98
    v_exp_f32 v101, v101
    ds_read_b64_tr_b16 v[184:185], v218 offset:45056
    ds_read_b64_tr_b16 v[186:187], v218 offset:47104
    s_waitcnt lgkmcnt(10)
    v_mfma_f32_32x32x16_bf16 v[16:31], v[196:199], v[168:171], v[16:31]
    v_add_f32 v223, v223, v99
    v_exp_f32 v102, v102
    v_add_f32 v223, v223, v100
    ds_read_b64_tr_b16 v[188:189], v219 offset:45056
    ds_read_b64_tr_b16 v[190:191], v219 offset:47104
    s_waitcnt lgkmcnt(10)
    v_mfma_f32_32x32x16_bf16 v[32:47], v[200:203], v[168:171], v[32:47]
    v_exp_f32 v103, v103
    v_add_f32 v223, v223, v101
    v_exp_f32 v104, v104
    v_add_f32 v223, v223, v102
    s_waitcnt lgkmcnt(8)
    v_mfma_f32_32x32x16_bf16 v[48:63], v[204:207], v[168:171], v[48:63]
    v_exp_f32 v105, v105
    v_add_f32 v223, v223, v103
    v_exp_f32 v106, v106
    s_waitcnt vmcnt(8) lgkmcnt(0)
    s_barrier
    s_add_u32 m0, s37, 98304
    s_nop 0
    buffer_load_dwordx4 v247, s[20:23], s39 offen nt lds
    buffer_load_dwordx4 v247, s[20:23], s39 offen offset:1024 nt lds
    s_add_u32 s39, s39, 16384
    s_and_b32 s39, s39, 0x3ffff
    s_add_u32 m0, s37, 49152
    s_nop 0
    buffer_load_dwordx4 v254, s[16:19], s38 offen nt lds
    buffer_load_dwordx4 v246, s[16:19], s38 offen offset:1024 nt lds
    s_add_u32 s38, s38, 16384
    s_and_b32 s38, s38, 0x3ffff
    ds_read_b128 v[192:195], v208 offset:0
    ds_read_b128 v[196:199], v209 offset:0
    v_mfma_f32_32x32x16_bf16 v[0:15], v[176:179], v[172:175], v[0:15]
    v_add_f32 v223, v223, v104
    v_exp_f32 v107, v107
    v_add_f32 v223, v223, v105
    ds_read_b128 v[200:203], v210 offset:0
    v_mfma_f32_32x32x16_bf16 v[16:31], v[180:183], v[172:175], v[16:31]
    v_exp_f32 v108, v108
    v_add_f32 v223, v223, v106
    v_exp_f32 v109, v109
    ds_read_b128 v[204:207], v211 offset:0
    v_mfma_f32_32x32x16_bf16 v[32:47], v[184:187], v[172:175], v[32:47]
    v_add_f32 v223, v223, v107
    v_exp_f32 v110, v110
    v_add_f32 v223, v223, v108
    v_exp_f32 v111, v111
    ds_read_b128 v[176:179], v212 offset:0
    v_mfma_f32_32x32x16_bf16 v[48:63], v[188:191], v[172:175], v[48:63]
    v_add_f32 v223, v223, v109
    v_add_f32 v223, v223, v110
    v_add_f32 v223, v223, v111
    ds_read_b128 v[180:183], v213 offset:0
    s_waitcnt lgkmcnt(5)
    v_mfma_f32_32x32x16_bf16 v[128:143], v[192:195], v[64:67], v[230:245]
    s_cmp_eq_u32 s42, 0
    s_cbranch_scc1 Lrs6
    s_nop 15
    v_mul_f32 v0, v224, v0
    v_mul_f32 v1, v224, v1
    v_mul_f32 v2, v224, v2
    v_mul_f32 v3, v224, v3
    v_mul_f32 v4, v224, v4
    v_mul_f32 v5, v224, v5
    v_mul_f32 v6, v224, v6
    v_mul_f32 v7, v224, v7
    v_mul_f32 v8, v224, v8
    v_mul_f32 v9, v224, v9
    v_mul_f32 v10, v224, v10
    v_mul_f32 v11, v224, v11
    v_mul_f32 v12, v224, v12
    v_mul_f32 v13, v224, v13
    v_mul_f32 v14, v224, v14
    v_mul_f32 v15, v224, v15
    v_mul_f32 v16, v224, v16
    v_mul_f32 v17, v224, v17
    v_mul_f32 v18, v224, v18
    v_mul_f32 v19, v224, v19
    v_mul_f32 v20, v224, v20
    v_mul_f32 v21, v224, v21
    v_mul_f32 v22, v224, v22
    v_mul_f32 v23, v224, v23
    v_mul_f32 v24, v224, v24
    v_mul_f32 v25, v224, v25
    v_mul_f32 v26, v224, v26
    v_mul_f32 v27, v224, v27
    v_mul_f32 v28, v224, v28
    v_mul_f32 v29, v224, v29
    v_mul_f32 v30, v224, v30
    v_mul_f32 v31, v224, v31
    v_mul_f32 v32, v224, v32
    v_mul_f32 v33, v224, v33
    v_mul_f32 v34, v224, v34
    v_mul_f32 v35, v224, v35
    v_mul_f32 v36, v224, v36
    v_mul_f32 v37, v224, v37
    v_mul_f32 v38, v224, v38
    v_mul_f32 v39, v224, v39
    v_mul_f32 v40, v224, v40
    v_mul_f32 v41, v224, v41
    v_mul_f32 v42, v224, v42
    v_mul_f32 v43, v224, v43
    v_mul_f32 v44, v224, v44
    v_mul_f32 v45, v224, v45
    v_mul_f32 v46, v224, v46
    v_mul_f32 v47, v224, v47
    v_mul_f32 v48, v224, v48
    v_mul_f32 v49, v224, v49
    v_mul_f32 v50, v224, v50
    v_mul_f32 v51, v224, v51
    v_mul_f32 v52, v224, v52
    v_mul_f32 v53, v224, v53
    v_mul_f32 v54, v224, v54
    v_mul_f32 v55, v224, v55
    v_mul_f32 v56, v224, v56
    v_mul_f32 v57, v224, v57
    v_mul_f32 v58, v224, v58
    v_mul_f32 v59, v224, v59
    v_mul_f32 v60, v224, v60
    v_mul_f32 v61, v224, v61
    v_mul_f32 v62, v224, v62
    v_mul_f32 v63, v224, v63
    v_mul_f32 v222, v224, v222
    s_mov_b32 s42, 0
    s_nop 1
Lrs6:
    v_cvt_pk_bf16_f32 v160, v96, v97
    v_cvt_pk_bf16_f32 v161, v98, v99
    v_cvt_pk_bf16_f32 v162, v100, v101
    ds_read_b128 v[184:187], v214 offset:0
    s_waitcnt lgkmcnt(5)
    v_mfma_f32_32x32x16_bf16 v[128:143], v[196:199], v[68:71], v[128:143]
    v_cvt_pk_bf16_f32 v163, v102, v103
    v_cvt_pk_bf16_f32 v164, v104, v105
    v_cvt_pk_bf16_f32 v165, v106, v107
    v_cvt_pk_bf16_f32 v166, v108, v109
    ds_read_b128 v[188:191], v215 offset:0
    s_waitcnt lgkmcnt(5)
    v_mfma_f32_32x32x16_bf16 v[128:143], v[200:203], v[72:75], v[128:143]
    v_cvt_pk_bf16_f32 v167, v110, v111
    v_exp_f32 v112, v112
    v_exp_f32 v113, v113
    ds_read_b128 v[192:195], v208 offset:8192
    s_waitcnt lgkmcnt(5)
    v_mfma_f32_32x32x16_bf16 v[128:143], v[204:207], v[76:79], v[128:143]
    v_exp_f32 v114, v114
    v_add_f32 v223, v223, v112
    v_exp_f32 v115, v115
    ds_read_b128 v[196:199], v209 offset:8192
    s_waitcnt lgkmcnt(5)
    v_mfma_f32_32x32x16_bf16 v[128:143], v[176:179], v[80:83], v[128:143]
    v_add_f32 v223, v223, v113
    v_exp_f32 v116, v116
    v_add_f32 v223, v223, v114
    ds_read_b128 v[200:203], v210 offset:8192
    s_waitcnt lgkmcnt(5)
    v_mfma_f32_32x32x16_bf16 v[128:143], v[180:183], v[84:87], v[128:143]
    v_exp_f32 v117, v117
    v_add_f32 v223, v223, v115
    v_exp_f32 v118, v118
    v_add_f32 v223, v223, v116
    ds_read_b128 v[204:207], v211 offset:8192
    s_waitcnt lgkmcnt(5)
    v_mfma_f32_32x32x16_bf16 v[128:143], v[184:187], v[88:91], v[128:143]
    v_exp_f32 v119, v119
    v_add_f32 v223, v223, v117
    v_exp_f32 v120, v120
    ds_read_b128 v[176:179], v212 offset:8192
    s_waitcnt lgkmcnt(5)
    v_mfma_f32_32x32x16_bf16 v[128:143], v[188:191], v[92:95], v[128:143]
    v_add_f32 v223, v223, v118
    v_exp_f32 v121, v121
    v_add_f32 v223, v223, v119
    ds_read_b128 v[180:183], v213 offset:8192
    s_waitcnt lgkmcnt(5)
    v_mfma_f32_32x32x16_bf16 v[144:159], v[192:195], v[64:67], v[230:245]
    v_exp_f32 v122, v122
    v_add_f32 v223, v223, v120
    v_exp_f32 v123, v123
    ds_read_b128 v[184:187], v214 offset:8192
    s_waitcnt lgkmcnt(5)
    v_mfma_f32_32x32x16_bf16 v[144:159], v[196:199], v[68:71], v[144:159]
    v_add_f32 v223, v223, v121
    v_exp_f32 v124, v124
    v_add_f32 v223, v223, v122
    v_exp_f32 v125, v125
    ds_read_b128 v[188:191], v215 offset:8192
    s_waitcnt lgkmcnt(5)
    v_mfma_f32_32x32x16_bf16 v[144:159], v[200:203], v[72:75], v[144:159]
    v_add_f32 v223, v223, v123
    v_exp_f32 v126, v126
    v_add_f32 v223, v223, v124
    ds_read_b64_tr_b16 v[192:193], v216 offset:49152
    ds_read_b64_tr_b16 v[194:195], v216 offset:51200
    s_waitcnt lgkmcnt(6)
    v_mfma_f32_32x32x16_bf16 v[144:159], v[204:207], v[76:79], v[144:159]
    v_exp_f32 v127, v127
    v_add_f32 v223, v223, v125
    v_add_f32 v223, v223, v126
    ds_read_b64_tr_b16 v[196:197], v217 offset:49152
    ds_read_b64_tr_b16 v[198:199], v217 offset:51200
    s_waitcnt lgkmcnt(7)
    v_mfma_f32_32x32x16_bf16 v[144:159], v[176:179], v[80:83], v[144:159]
    v_add_f32 v223, v223, v127
    v_cvt_pk_bf16_f32 v168, v112, v113
    v_cvt_pk_bf16_f32 v169, v114, v115
    ds_read_b64_tr_b16 v[200:201], v218 offset:49152
    ds_read_b64_tr_b16 v[202:203], v218 offset:51200
    s_waitcnt lgkmcnt(8)
    v_mfma_f32_32x32x16_bf16 v[144:159], v[180:183], v[84:87], v[144:159]
    v_cvt_pk_bf16_f32 v170, v116, v117
    v_cvt_pk_bf16_f32 v171, v118, v119
    v_cvt_pk_bf16_f32 v172, v120, v121
    v_cvt_pk_bf16_f32 v173, v122, v123
    ds_read_b64_tr_b16 v[204:205], v219 offset:49152
    ds_read_b64_tr_b16 v[206:207], v219 offset:51200
    s_waitcnt lgkmcnt(9)
    v_mfma_f32_32x32x16_bf16 v[144:159], v[184:187], v[88:91], v[144:159]
    v_cvt_pk_bf16_f32 v174, v124, v125
    v_cvt_pk_bf16_f32 v175, v126, v127
    v_add_f32 v222, v222, v223
    ds_read_b64_tr_b16 v[176:177], v216 offset:53248
    ds_read_b64_tr_b16 v[178:179], v216 offset:55296
    s_waitcnt lgkmcnt(10)
    v_mfma_f32_32x32x16_bf16 v[144:159], v[188:191], v[92:95], v[144:159]
    ds_read_b64_tr_b16 v[180:181], v217 offset:53248
    ds_read_b64_tr_b16 v[182:183], v217 offset:55296
    s_waitcnt lgkmcnt(10)
    v_mfma_f32_32x32x16_bf16 v[0:15], v[192:195], v[160:163], v[0:15]
    v_max3_f32 v225, v128, v129, v130
    v_max3_f32 v226, v131, v132, v133
    v_max3_f32 v225, v225, v134, v135
    ds_read_b64_tr_b16 v[184:185], v218 offset:53248
    ds_read_b64_tr_b16 v[186:187], v218 offset:55296
    s_waitcnt lgkmcnt(10)
    v_mfma_f32_32x32x16_bf16 v[16:31], v[196:199], v[160:163], v[16:31]
    v_max3_f32 v226, v226, v136, v137
    v_max3_f32 v225, v225, v138, v139
    v_max3_f32 v226, v226, v140, v141
    ds_read_b64_tr_b16 v[188:189], v219 offset:53248
    ds_read_b64_tr_b16 v[190:191], v219 offset:55296
    s_waitcnt lgkmcnt(10)
    v_mfma_f32_32x32x16_bf16 v[32:47], v[200:203], v[160:163], v[32:47]
    v_max3_f32 v225, v225, v142, v143
    v_max3_f32 v226, v226, v144, v145
    v_max3_f32 v225, v225, v146, v147
    v_max3_f32 v226, v226, v148, v149
    ds_read_b64_tr_b16 v[192:193], v216 offset:57344
    ds_read_b64_tr_b16 v[194:195], v216 offset:59392
    s_waitcnt lgkmcnt(10)
    v_mfma_f32_32x32x16_bf16 v[48:63], v[204:207], v[160:163], v[48:63]
    v_max3_f32 v225, v225, v150, v151
    v_max3_f32 v226, v226, v152, v153
    v_max3_f32 v225, v225, v154, v155
    ds_read_b64_tr_b16 v[196:197], v217 offset:57344
    ds_read_b64_tr_b16 v[198:199], v217 offset:59392
    s_waitcnt lgkmcnt(10)
    v_mfma_f32_32x32x16_bf16 v[0:15], v[176:179], v[164:167], v[0:15]
    v_max3_f32 v226, v226, v156, v157
    v_max3_f32 v225, v225, v158, v159
    v_max_f32 v225, v225, v226
    ds_read_b64_tr_b16 v[200:201], v218 offset:57344
    ds_read_b64_tr_b16 v[202:203], v218 offset:59392
    s_waitcnt lgkmcnt(10)
    v_mfma_f32_32x32x16_bf16 v[16:31], v[180:183], v[164:167], v[16:31]
    v_mov_b32 v226, v225
    s_nop 1
    v_permlane32_swap_b32 v225, v226
    v_max_f32 v225, v225, v226
    v_cmp_lt_f32 vcc, s41, v225
    s_cbranch_vccz Ldec7
    v_max_f32 v226, s49, v225
    v_sub_f32 v227, 0, v226
    v_min_f32 v227, 0, v227
    v_exp_f32 v224, v227
    v_sub_f32 v128, v128, v226
    v_sub_f32 v129, v129, v226
    v_sub_f32 v130, v130, v226
    v_sub_f32 v131, v131, v226
    v_sub_f32 v132, v132, v226
    v_sub_f32 v133, v133, v226
    v_sub_f32 v134, v134, v226
    v_sub_f32 v135, v135, v226
    v_sub_f32 v136, v136, v226
    v_sub_f32 v137, v137, v226
    v_sub_f32 v138, v138, v226
    v_sub_f32 v139, v139, v226
    v_sub_f32 v140, v140, v226
    v_sub_f32 v141, v141, v226
    v_sub_f32 v142, v142, v226
    v_sub_f32 v143, v143, v226
    v_sub_f32 v144, v144, v226
    v_sub_f32 v145, v145, v226
    v_sub_f32 v146, v146, v226
    v_sub_f32 v147, v147, v226
    v_sub_f32 v148, v148, v226
    v_sub_f32 v149, v149, v226
    v_sub_f32 v150, v150, v226
    v_sub_f32 v151, v151, v226
    v_sub_f32 v152, v152, v226
    v_sub_f32 v153, v153, v226
    v_sub_f32 v154, v154, v226
    v_sub_f32 v155, v155, v226
    v_sub_f32 v156, v156, v226
    v_sub_f32 v157, v157, v226
    v_sub_f32 v158, v158, v226
    v_sub_f32 v159, v159, v226
    v_sub_f32 v230, v230, v226
    v_sub_f32 v231, v231, v226
    v_sub_f32 v232, v232, v226
    v_sub_f32 v233, v233, v226
    v_sub_f32 v234, v234, v226
    v_sub_f32 v235, v235, v226
    v_sub_f32 v236, v236, v226
    v_sub_f32 v237, v237, v226
    v_sub_f32 v238, v238, v226
    v_sub_f32 v239, v239, v226
    v_sub_f32 v240, v240, v226
    v_sub_f32 v241, v241, v226
    v_sub_f32 v242, v242, v226
    v_sub_f32 v243, v243, v226
    v_sub_f32 v244, v244, v226
    v_sub_f32 v245, v245, v226
    s_mov_b32 s42, 1
    s_mov_b32 s41, 0x41000000
    s_mov_b32 s49, 0
Ldec7:
    ds_read_b64_tr_b16 v[204:205], v219 offset:57344
    ds_read_b64_tr_b16 v[206:207], v219 offset:59392
    s_waitcnt lgkmcnt(10)
    v_mfma_f32_32x32x16_bf16 v[32:47], v[184:187], v[164:167], v[32:47]
    v_exp_f32 v128, v128
    v_exp_f32 v129, v129
    v_exp_f32 v130, v130
    ds_read_b64_tr_b16 v[176:177], v216 offset:61440
    ds_read_b64_tr_b16 v[178:179], v216 offset:63488
    s_waitcnt lgkmcnt(10)
    v_mfma_f32_32x32x16_bf16 v[48:63], v[188:191], v[164:167], v[48:63]
    v_mov_b32 v223, v128
    v_exp_f32 v131, v131
    v_add_f32 v223, v223, v129
    ds_read_b64_tr_b16 v[180:181], v217 offset:61440
    ds_read_b64_tr_b16 v[182:183], v217 offset:63488
    s_waitcnt lgkmcnt(10)
    v_mfma_f32_32x32x16_bf16 v[0:15], v[192:195], v[168:171], v[0:15]
    v_exp_f32 v132, v132
    v_add_f32 v223, v223, v130
    v_exp_f32 v133, v133
    ds_read_b64_tr_b16 v[184:185], v218 offset:61440
    ds_read_b64_tr_b16 v[186:187], v218 offset:63488
    s_waitcnt lgkmcnt(10)
    v_mfma_f32_32x32x16_bf16 v[16:31], v[196:199], v[168:171], v[16:31]
    v_add_f32 v223, v223, v131
    v_exp_f32 v134, v134
    v_add_f32 v223, v223, v132
    ds_read_b64_tr_b16 v[188:189], v219 offset:61440
    ds_read_b64_tr_b16 v[190:191], v219 offset:63488
    s_waitcnt lgkmcnt(10)
    v_mfma_f32_32x32x16_bf16 v[32:47], v[200:203], v[168:171], v[32:47]
    v_exp_f32 v135, v135
    v_add_f32 v223, v223, v133
    v_exp_f32 v136, v136
    v_add_f32 v223, v223, v134
    s_waitcnt lgkmcnt(8)
    v_mfma_f32_32x32x16_bf16 v[48:63], v[204:207], v[168:171], v[48:63]
    v_exp_f32 v137, v137
    v_add_f32 v223, v223, v135
    v_exp_f32 v138, v138
    s_waitcnt vmcnt(8) lgkmcnt(0)
    s_barrier
    s_add_u32 m0, s37, 114688
    s_nop 0
    buffer_load_dwordx4 v247, s[20:23], s39 offen nt lds
    buffer_load_dwordx4 v247, s[20:23], s39 offen offset:1024 nt lds
    s_add_u32 s39, s39, 16384
    s_and_b32 s39, s39, 0x3ffff
    s_add_u32 m0, s37, 0
    s_nop 0
    buffer_load_dwordx4 v254, s[16:19], s38 offen nt lds
    buffer_load_dwordx4 v246, s[16:19], s38 offen offset:1024 nt lds
    s_add_u32 s38, s38, 16384
    s_and_b32 s38, s38, 0x3ffff
    ds_read_b128 v[192:195], v208 offset:16384
    ds_read_b128 v[196:199], v209 offset:16384
    v_mfma_f32_32x32x16_bf16 v[0:15], v[176:179], v[172:175], v[0:15]
    v_add_f32 v223, v223, v136
    v_exp_f32 v139, v139
    v_add_f32 v223, v223, v137
    ds_read_b128 v[200:203], v210 offset:16384
    v_mfma_f32_32x32x16_bf16 v[16:31], v[180:183], v[172:175], v[16:31]
    v_exp_f32 v140, v140
    v_add_f32 v223, v223, v138
    v_exp_f32 v141, v141
    ds_read_b128 v[204:207], v211 offset:16384
    v_mfma_f32_32x32x16_bf16 v[32:47], v[184:187], v[172:175], v[32:47]
    v_add_f32 v223, v223, v139
    v_exp_f32 v142, v142
    v_add_f32 v223, v223, v140
    v_exp_f32 v143, v143
    ds_read_b128 v[176:179], v212 offset:16384
    v_mfma_f32_32x32x16_bf16 v[48:63], v[188:191], v[172:175], v[48:63]
    v_add_f32 v223, v223, v141
    v_add_f32 v223, v223, v142
    v_add_f32 v223, v223, v143
    ds_read_b128 v[180:183], v213 offset:16384
    s_waitcnt lgkmcnt(5)
    v_mfma_f32_32x32x16_bf16 v[96:111], v[192:195], v[64:67], v[230:245]
    s_cmp_eq_u32 s42, 0
    s_cbranch_scc1 Lrs8
    s_nop 15
    v_mul_f32 v0, v224, v0
    v_mul_f32 v1, v224, v1
    v_mul_f32 v2, v224, v2
    v_mul_f32 v3, v224, v3
    v_mul_f32 v4, v224, v4
    v_mul_f32 v5, v224, v5
    v_mul_f32 v6, v224, v6
    v_mul_f32 v7, v224, v7
    v_mul_f32 v8, v224, v8
    v_mul_f32 v9, v224, v9
    v_mul_f32 v10, v224, v10
    v_mul_f32 v11, v224, v11
    v_mul_f32 v12, v224, v12
    v_mul_f32 v13, v224, v13
    v_mul_f32 v14, v224, v14
    v_mul_f32 v15, v224, v15
    v_mul_f32 v16, v224, v16
    v_mul_f32 v17, v224, v17
    v_mul_f32 v18, v224, v18
    v_mul_f32 v19, v224, v19
    v_mul_f32 v20, v224, v20
    v_mul_f32 v21, v224, v21
    v_mul_f32 v22, v224, v22
    v_mul_f32 v23, v224, v23
    v_mul_f32 v24, v224, v24
    v_mul_f32 v25, v224, v25
    v_mul_f32 v26, v224, v26
    v_mul_f32 v27, v224, v27
    v_mul_f32 v28, v224, v28
    v_mul_f32 v29, v224, v29
    v_mul_f32 v30, v224, v30
    v_mul_f32 v31, v224, v31
    v_mul_f32 v32, v224, v32
    v_mul_f32 v33, v224, v33
    v_mul_f32 v34, v224, v34
    v_mul_f32 v35, v224, v35
    v_mul_f32 v36, v224, v36
    v_mul_f32 v37, v224, v37
    v_mul_f32 v38, v224, v38
    v_mul_f32 v39, v224, v39
    v_mul_f32 v40, v224, v40
    v_mul_f32 v41, v224, v41
    v_mul_f32 v42, v224, v42
    v_mul_f32 v43, v224, v43
    v_mul_f32 v44, v224, v44
    v_mul_f32 v45, v224, v45
    v_mul_f32 v46, v224, v46
    v_mul_f32 v47, v224, v47
    v_mul_f32 v48, v224, v48
    v_mul_f32 v49, v224, v49
    v_mul_f32 v50, v224, v50
    v_mul_f32 v51, v224, v51
    v_mul_f32 v52, v224, v52
    v_mul_f32 v53, v224, v53
    v_mul_f32 v54, v224, v54
    v_mul_f32 v55, v224, v55
    v_mul_f32 v56, v224, v56
    v_mul_f32 v57, v224, v57
    v_mul_f32 v58, v224, v58
    v_mul_f32 v59, v224, v59
    v_mul_f32 v60, v224, v60
    v_mul_f32 v61, v224, v61
    v_mul_f32 v62, v224, v62
    v_mul_f32 v63, v224, v63
    v_mul_f32 v222, v224, v222
    s_mov_b32 s42, 0
    s_nop 1
Lrs8:
    v_cvt_pk_bf16_f32 v160, v128, v129
    v_cvt_pk_bf16_f32 v161, v130, v131
    v_cvt_pk_bf16_f32 v162, v132, v133
    ds_read_b128 v[184:187], v214 offset:16384
    s_waitcnt lgkmcnt(5)
    v_mfma_f32_32x32x16_bf16 v[96:111], v[196:199], v[68:71], v[96:111]
    v_cvt_pk_bf16_f32 v163, v134, v135
    v_cvt_pk_bf16_f32 v164, v136, v137
    v_cvt_pk_bf16_f32 v165, v138, v139
    v_cvt_pk_bf16_f32 v166, v140, v141
    ds_read_b128 v[188:191], v215 offset:16384
    s_waitcnt lgkmcnt(5)
    v_mfma_f32_32x32x16_bf16 v[96:111], v[200:203], v[72:75], v[96:111]
    v_cvt_pk_bf16_f32 v167, v142, v143
    v_exp_f32 v144, v144
    v_exp_f32 v145, v145
    ds_read_b128 v[192:195], v208 offset:24576
    s_waitcnt lgkmcnt(5)
    v_mfma_f32_32x32x16_bf16 v[96:111], v[204:207], v[76:79], v[96:111]
    v_exp_f32 v146, v146
    v_add_f32 v223, v223, v144
    v_exp_f32 v147, v147
    ds_read_b128 v[196:199], v209 offset:24576
    s_waitcnt lgkmcnt(5)
    v_mfma_f32_32x32x16_bf16 v[96:111], v[176:179], v[80:83], v[96:111]
    v_add_f32 v223, v223, v145
    v_exp_f32 v148, v148
    v_add_f32 v223, v223, v146
    ds_read_b128 v[200:203], v210 offset:24576
    s_waitcnt lgkmcnt(5)
    v_mfma_f32_32x32x16_bf16 v[96:111], v[180:183], v[84:87], v[96:111]
    v_exp_f32 v149, v149
    v_add_f32 v223, v223, v147
    v_exp_f32 v150, v150
    v_add_f32 v223, v223, v148
    ds_read_b128 v[204:207], v211 offset:24576
    s_waitcnt lgkmcnt(5)
    v_mfma_f32_32x32x16_bf16 v[96:111], v[184:187], v[88:91], v[96:111]
    v_exp_f32 v151, v151
    v_add_f32 v223, v223, v149
    v_exp_f32 v152, v152
    ds_read_b128 v[176:179], v212 offset:24576
    s_waitcnt lgkmcnt(5)
    v_mfma_f32_32x32x16_bf16 v[96:111], v[188:191], v[92:95], v[96:111]
    v_add_f32 v223, v223, v150
    v_exp_f32 v153, v153
    v_add_f32 v223, v223, v151
    ds_read_b128 v[180:183], v213 offset:24576
    s_waitcnt lgkmcnt(5)
    v_mfma_f32_32x32x16_bf16 v[112:127], v[192:195], v[64:67], v[230:245]
    v_exp_f32 v154, v154
    v_add_f32 v223, v223, v152
    v_exp_f32 v155, v155
    ds_read_b128 v[184:187], v214 offset:24576
    s_waitcnt lgkmcnt(5)
    v_mfma_f32_32x32x16_bf16 v[112:127], v[196:199], v[68:71], v[112:127]
    v_add_f32 v223, v223, v153
    v_exp_f32 v156, v156
    v_add_f32 v223, v223, v154
    v_exp_f32 v157, v157
    ds_read_b128 v[188:191], v215 offset:24576
    s_waitcnt lgkmcnt(5)
    v_mfma_f32_32x32x16_bf16 v[112:127], v[200:203], v[72:75], v[112:127]
    v_add_f32 v223, v223, v155
    v_exp_f32 v158, v158
    v_add_f32 v223, v223, v156
    ds_read_b64_tr_b16 v[192:193], v216 offset:0
    ds_read_b64_tr_b16 v[194:195], v216 offset:2048
    s_waitcnt lgkmcnt(6)
    v_mfma_f32_32x32x16_bf16 v[112:127], v[204:207], v[76:79], v[112:127]
    v_exp_f32 v159, v159
    v_add_f32 v223, v223, v157
    v_add_f32 v223, v223, v158
    ds_read_b64_tr_b16 v[196:197], v217 offset:0
    ds_read_b64_tr_b16 v[198:199], v217 offset:2048
    s_waitcnt lgkmcnt(7)
    v_mfma_f32_32x32x16_bf16 v[112:127], v[176:179], v[80:83], v[112:127]
    v_add_f32 v223, v223, v159
    v_cvt_pk_bf16_f32 v168, v144, v145
    v_cvt_pk_bf16_f32 v169, v146, v147
    ds_read_b64_tr_b16 v[200:201], v218 offset:0
    ds_read_b64_tr_b16 v[202:203], v218 offset:2048
    s_waitcnt lgkmcnt(8)
    v_mfma_f32_32x32x16_bf16 v[112:127], v[180:183], v[84:87], v[112:127]
    v_cvt_pk_bf16_f32 v170, v148, v149
    v_cvt_pk_bf16_f32 v171, v150, v151
    v_cvt_pk_bf16_f32 v172, v152, v153
    v_cvt_pk_bf16_f32 v173, v154, v155
    ds_read_b64_tr_b16 v[204:205], v219 offset:0
    ds_read_b64_tr_b16 v[206:207], v219 offset:2048
    s_waitcnt lgkmcnt(9)
    v_mfma_f32_32x32x16_bf16 v[112:127], v[184:187], v[88:91], v[112:127]
    v_cvt_pk_bf16_f32 v174, v156, v157
    v_cvt_pk_bf16_f32 v175, v158, v159
    v_add_f32 v222, v222, v223
    ds_read_b64_tr_b16 v[176:177], v216 offset:4096
    ds_read_b64_tr_b16 v[178:179], v216 offset:6144
    s_waitcnt lgkmcnt(10)
    v_mfma_f32_32x32x16_bf16 v[112:127], v[188:191], v[92:95], v[112:127]
    ds_read_b64_tr_b16 v[180:181], v217 offset:4096
    ds_read_b64_tr_b16 v[182:183], v217 offset:6144
    s_waitcnt lgkmcnt(10)
    v_mfma_f32_32x32x16_bf16 v[0:15], v[192:195], v[160:163], v[0:15]
    v_max3_f32 v225, v96, v97, v98
    v_max3_f32 v226, v99, v100, v101
    v_max3_f32 v225, v225, v102, v103
    ds_read_b64_tr_b16 v[184:185], v218 offset:4096
    ds_read_b64_tr_b16 v[186:187], v218 offset:6144
    s_waitcnt lgkmcnt(10)
    v_mfma_f32_32x32x16_bf16 v[16:31], v[196:199], v[160:163], v[16:31]
    v_max3_f32 v226, v226, v104, v105
    v_max3_f32 v225, v225, v106, v107
    v_max3_f32 v226, v226, v108, v109
    ds_read_b64_tr_b16 v[188:189], v219 offset:4096
    ds_read_b64_tr_b16 v[190:191], v219 offset:6144
    s_waitcnt lgkmcnt(10)
    v_mfma_f32_32x32x16_bf16 v[32:47], v[200:203], v[160:163], v[32:47]
    v_max3_f32 v225, v225, v110, v111
    v_max3_f32 v226, v226, v112, v113
    v_max3_f32 v225, v225, v114, v115
    v_max3_f32 v226, v226, v116, v117
    ds_read_b64_tr_b16 v[192:193], v216 offset:8192
    ds_read_b64_tr_b16 v[194:195], v216 offset:10240
    s_waitcnt lgkmcnt(10)
    v_mfma_f32_32x32x16_bf16 v[48:63], v[204:207], v[160:163], v[48:63]
    v_max3_f32 v225, v225, v118, v119
    v_max3_f32 v226, v226, v120, v121
    v_max3_f32 v225, v225, v122, v123
    ds_read_b64_tr_b16 v[196:197], v217 offset:8192
    ds_read_b64_tr_b16 v[198:199], v217 offset:10240
    s_waitcnt lgkmcnt(10)
    v_mfma_f32_32x32x16_bf16 v[0:15], v[176:179], v[164:167], v[0:15]
    v_max3_f32 v226, v226, v124, v125
    v_max3_f32 v225, v225, v126, v127
    v_max_f32 v225, v225, v226
    ds_read_b64_tr_b16 v[200:201], v218 offset:8192
    ds_read_b64_tr_b16 v[202:203], v218 offset:10240
    s_waitcnt lgkmcnt(10)
    v_mfma_f32_32x32x16_bf16 v[16:31], v[180:183], v[164:167], v[16:31]
    v_mov_b32 v226, v225
    s_nop 1
    v_permlane32_swap_b32 v225, v226
    v_max_f32 v225, v225, v226
    v_cmp_lt_f32 vcc, s41, v225
    s_cbranch_vccz Ldec9
    v_max_f32 v226, s49, v225
    v_sub_f32 v227, 0, v226
    v_min_f32 v227, 0, v227
    v_exp_f32 v224, v227
    v_sub_f32 v96, v96, v226
    v_sub_f32 v97, v97, v226
    v_sub_f32 v98, v98, v226
    v_sub_f32 v99, v99, v226
    v_sub_f32 v100, v100, v226
    v_sub_f32 v101, v101, v226
    v_sub_f32 v102, v102, v226
    v_sub_f32 v103, v103, v226
    v_sub_f32 v104, v104, v226
    v_sub_f32 v105, v105, v226
    v_sub_f32 v106, v106, v226
    v_sub_f32 v107, v107, v226
    v_sub_f32 v108, v108, v226
    v_sub_f32 v109, v109, v226
    v_sub_f32 v110, v110, v226
    v_sub_f32 v111, v111, v226
    v_sub_f32 v112, v112, v226
    v_sub_f32 v113, v113, v226
    v_sub_f32 v114, v114, v226
    v_sub_f32 v115, v115, v226
    v_sub_f32 v116, v116, v226
    v_sub_f32 v117, v117, v226
    v_sub_f32 v118, v118, v226
    v_sub_f32 v119, v119, v226
    v_sub_f32 v120, v120, v226
    v_sub_f32 v121, v121, v226
    v_sub_f32 v122, v122, v226
    v_sub_f32 v123, v123, v226
    v_sub_f32 v124, v124, v226
    v_sub_f32 v125, v125, v226
    v_sub_f32 v126, v126, v226
    v_sub_f32 v127, v127, v226
    v_sub_f32 v230, v230, v226
    v_sub_f32 v231, v231, v226
    v_sub_f32 v232, v232, v226
    v_sub_f32 v233, v233, v226
    v_sub_f32 v234, v234, v226
    v_sub_f32 v235, v235, v226
    v_sub_f32 v236, v236, v226
    v_sub_f32 v237, v237, v226
    v_sub_f32 v238, v238, v226
    v_sub_f32 v239, v239, v226
    v_sub_f32 v240, v240, v226
    v_sub_f32 v241, v241, v226
    v_sub_f32 v242, v242, v226
    v_sub_f32 v243, v243, v226
    v_sub_f32 v244, v244, v226
    v_sub_f32 v245, v245, v226
    s_mov_b32 s42, 1
    s_mov_b32 s41, 0x41000000
    s_mov_b32 s49, 0
Ldec9:
    ds_read_b64_tr_b16 v[204:205], v219 offset:8192
    ds_read_b64_tr_b16 v[206:207], v219 offset:10240
    s_waitcnt lgkmcnt(10)
    v_mfma_f32_32x32x16_bf16 v[32:47], v[184:187], v[164:167], v[32:47]
    v_exp_f32 v96, v96
    v_exp_f32 v97, v97
    v_exp_f32 v98, v98
    ds_read_b64_tr_b16 v[176:177], v216 offset:12288
    ds_read_b64_tr_b16 v[178:179], v216 offset:14336
    s_waitcnt lgkmcnt(10)
    v_mfma_f32_32x32x16_bf16 v[48:63], v[188:191], v[164:167], v[48:63]
    v_mov_b32 v223, v96
    v_exp_f32 v99, v99
    v_add_f32 v223, v223, v97
    ds_read_b64_tr_b16 v[180:181], v217 offset:12288
    ds_read_b64_tr_b16 v[182:183], v217 offset:14336
    s_waitcnt lgkmcnt(10)
    v_mfma_f32_32x32x16_bf16 v[0:15], v[192:195], v[168:171], v[0:15]
    v_exp_f32 v100, v100
    v_add_f32 v223, v223, v98
    v_exp_f32 v101, v101
    ds_read_b64_tr_b16 v[184:185], v218 offset:12288
    ds_read_b64_tr_b16 v[186:187], v218 offset:14336
    s_waitcnt lgkmcnt(10)
    v_mfma_f32_32x32x16_bf16 v[16:31], v[196:199], v[168:171], v[16:31]
    v_add_f32 v223, v223, v99
    v_exp_f32 v102, v102
    v_add_f32 v223, v223, v100
    ds_read_b64_tr_b16 v[188:189], v219 offset:12288
    ds_read_b64_tr_b16 v[190:191], v219 offset:14336
    s_waitcnt lgkmcnt(10)
    v_mfma_f32_32x32x16_bf16 v[32:47], v[200:203], v[168:171], v[32:47]
    v_exp_f32 v103, v103
    v_add_f32 v223, v223, v101
    v_exp_f32 v104, v104
    v_add_f32 v223, v223, v102
    s_waitcnt lgkmcnt(8)
    v_mfma_f32_32x32x16_bf16 v[48:63], v[204:207], v[168:171], v[48:63]
    v_exp_f32 v105, v105
    v_add_f32 v223, v223, v103
    v_exp_f32 v106, v106
    s_add_u32 s43, s43, 1
    s_cmp_lt_u32 s43, 3
    s_cbranch_scc1 Lmain
    s_waitcnt vmcnt(8) lgkmcnt(0)
    s_barrier
    s_add_u32 m0, s37, 65536
    s_nop 0
    buffer_load_dwordx4 v247, s[20:23], s39 offen nt lds
    buffer_load_dwordx4 v247, s[20:23], s39 offen offset:1024 nt lds
    s_add_u32 s39, s39, 16384
    s_and_b32 s39, s39, 0x3ffff
    s_add_u32 m0, s37, 16384
    s_mov_b32 s54, 524288
    s_mov_b32 s55, 556032
    buffer_load_dwordx4 v228, s[12:15], s54 offen lds
    buffer_load_dwordx4 v228, s[12:15], s55 offen offset:1024 lds
    ds_read_b128 v[192:195], v208 offset:32768
    ds_read_b128 v[196:199], v209 offset:32768
    v_mfma_f32_32x32x16_bf16 v[0:15], v[176:179], v[172:175], v[0:15]
    v_add_f32 v223, v223, v104
    v_exp_f32 v107, v107
    v_add_f32 v223, v223, v105
    ds_read_b128 v[200:203], v210 offset:32768
    v_mfma_f32_32x32x16_bf16 v[16:31], v[180:183], v[172:175], v[16:31]
    v_exp_f32 v108, v108
    v_add_f32 v223, v223, v106
    v_exp_f32 v109, v109
    ds_read_b128 v[204:207], v211 offset:32768
    v_mfma_f32_32x32x16_bf16 v[32:47], v[184:187], v[172:175], v[32:47]
    v_add_f32 v223, v223, v107
    v_exp_f32 v110, v110
    v_add_f32 v223, v223, v108
    v_exp_f32 v111, v111
    ds_read_b128 v[176:179], v212 offset:32768
    v_mfma_f32_32x32x16_bf16 v[48:63], v[188:191], v[172:175], v[48:63]
    v_add_f32 v223, v223, v109
    v_add_f32 v223, v223, v110
    v_add_f32 v223, v223, v111
    ds_read_b128 v[180:183], v213 offset:32768
    s_waitcnt lgkmcnt(5)
    v_mfma_f32_32x32x16_bf16 v[128:143], v[192:195], v[64:67], v[230:245]
    s_cmp_eq_u32 s42, 0
    s_cbranch_scc1 Lrs10
    s_nop 15
    v_mul_f32 v0, v224, v0
    v_mul_f32 v1, v224, v1
    v_mul_f32 v2, v224, v2
    v_mul_f32 v3, v224, v3
    v_mul_f32 v4, v224, v4
    v_mul_f32 v5, v224, v5
    v_mul_f32 v6, v224, v6
    v_mul_f32 v7, v224, v7
    v_mul_f32 v8, v224, v8
    v_mul_f32 v9, v224, v9
    v_mul_f32 v10, v224, v10
    v_mul_f32 v11, v224, v11
    v_mul_f32 v12, v224, v12
    v_mul_f32 v13, v224, v13
    v_mul_f32 v14, v224, v14
    v_mul_f32 v15, v224, v15
    v_mul_f32 v16, v224, v16
    v_mul_f32 v17, v224, v17
    v_mul_f32 v18, v224, v18
    v_mul_f32 v19, v224, v19
    v_mul_f32 v20, v224, v20
    v_mul_f32 v21, v224, v21
    v_mul_f32 v22, v224, v22
    v_mul_f32 v23, v224, v23
    v_mul_f32 v24, v224, v24
    v_mul_f32 v25, v224, v25
    v_mul_f32 v26, v224, v26
    v_mul_f32 v27, v224, v27
    v_mul_f32 v28, v224, v28
    v_mul_f32 v29, v224, v29
    v_mul_f32 v30, v224, v30
    v_mul_f32 v31, v224, v31
    v_mul_f32 v32, v224, v32
    v_mul_f32 v33, v224, v33
    v_mul_f32 v34, v224, v34
    v_mul_f32 v35, v224, v35
    v_mul_f32 v36, v224, v36
    v_mul_f32 v37, v224, v37
    v_mul_f32 v38, v224, v38
    v_mul_f32 v39, v224, v39
    v_mul_f32 v40, v224, v40
    v_mul_f32 v41, v224, v41
    v_mul_f32 v42, v224, v42
    v_mul_f32 v43, v224, v43
    v_mul_f32 v44, v224, v44
    v_mul_f32 v45, v224, v45
    v_mul_f32 v46, v224, v46
    v_mul_f32 v47, v224, v47
    v_mul_f32 v48, v224, v48
    v_mul_f32 v49, v224, v49
    v_mul_f32 v50, v224, v50
    v_mul_f32 v51, v224, v51
    v_mul_f32 v52, v224, v52
    v_mul_f32 v53, v224, v53
    v_mul_f32 v54, v224, v54
    v_mul_f32 v55, v224, v55
    v_mul_f32 v56, v224, v56
    v_mul_f32 v57, v224, v57
    v_mul_f32 v58, v224, v58
    v_mul_f32 v59, v224, v59
    v_mul_f32 v60, v224, v60
    v_mul_f32 v61, v224, v61
    v_mul_f32 v62, v224, v62
    v_mul_f32 v63, v224, v63
    v_mul_f32 v222, v224, v222
    s_mov_b32 s42, 0
    s_nop 1
Lrs10:
    v_cvt_pk_bf16_f32 v160, v96, v97
    v_cvt_pk_bf16_f32 v161, v98, v99
    v_cvt_pk_bf16_f32 v162, v100, v101
    ds_read_b128 v[184:187], v214 offset:32768
    s_waitcnt lgkmcnt(5)
    v_mfma_f32_32x32x16_bf16 v[128:143], v[196:199], v[68:71], v[128:143]
    v_cvt_pk_bf16_f32 v163, v102, v103
    v_cvt_pk_bf16_f32 v164, v104, v105
    v_cvt_pk_bf16_f32 v165, v106, v107
    v_cvt_pk_bf16_f32 v166, v108, v109
    ds_read_b128 v[188:191], v215 offset:32768
    s_waitcnt lgkmcnt(5)
    v_mfma_f32_32x32x16_bf16 v[128:143], v[200:203], v[72:75], v[128:143]
    v_cvt_pk_bf16_f32 v167, v110, v111
    v_exp_f32 v112, v112
    v_exp_f32 v113, v113
    ds_read_b128 v[192:195], v208 offset:40960
    s_waitcnt lgkmcnt(5)
    v_mfma_f32_32x32x16_bf16 v[128:143], v[204:207], v[76:79], v[128:143]
    v_exp_f32 v114, v114
    v_add_f32 v223, v223, v112
    v_exp_f32 v115, v115
    ds_read_b128 v[196:199], v209 offset:40960
    s_waitcnt lgkmcnt(5)
    v_mfma_f32_32x32x16_bf16 v[128:143], v[176:179], v[80:83], v[128:143]
    v_add_f32 v223, v223, v113
    v_exp_f32 v116, v116
    v_add_f32 v223, v223, v114
    ds_read_b128 v[200:203], v210 offset:40960
    s_waitcnt lgkmcnt(5)
    v_mfma_f32_32x32x16_bf16 v[128:143], v[180:183], v[84:87], v[128:143]
    v_exp_f32 v117, v117
    v_add_f32 v223, v223, v115
    v_exp_f32 v118, v118
    v_add_f32 v223, v223, v116
    ds_read_b128 v[204:207], v211 offset:40960
    s_waitcnt lgkmcnt(5)
    v_mfma_f32_32x32x16_bf16 v[128:143], v[184:187], v[88:91], v[128:143]
    v_exp_f32 v119, v119
    v_add_f32 v223, v223, v117
    v_exp_f32 v120, v120
    ds_read_b128 v[176:179], v212 offset:40960
    s_waitcnt lgkmcnt(5)
    v_mfma_f32_32x32x16_bf16 v[128:143], v[188:191], v[92:95], v[128:143]
    v_add_f32 v223, v223, v118
    v_exp_f32 v121, v121
    v_add_f32 v223, v223, v119
    ds_read_b128 v[180:183], v213 offset:40960
    s_waitcnt lgkmcnt(5)
    v_mfma_f32_32x32x16_bf16 v[144:159], v[192:195], v[64:67], v[230:245]
    v_exp_f32 v122, v122
    v_add_f32 v223, v223, v120
    v_exp_f32 v123, v123
    ds_read_b128 v[184:187], v214 offset:40960
    s_waitcnt lgkmcnt(5)
    v_mfma_f32_32x32x16_bf16 v[144:159], v[196:199], v[68:71], v[144:159]
    v_add_f32 v223, v223, v121
    v_exp_f32 v124, v124
    v_add_f32 v223, v223, v122
    v_exp_f32 v125, v125
    ds_read_b128 v[188:191], v215 offset:40960
    s_waitcnt lgkmcnt(5)
    v_mfma_f32_32x32x16_bf16 v[144:159], v[200:203], v[72:75], v[144:159]
    v_add_f32 v223, v223, v123
    v_exp_f32 v126, v126
    v_add_f32 v223, v223, v124
    ds_read_b64_tr_b16 v[192:193], v216 offset:16384
    ds_read_b64_tr_b16 v[194:195], v216 offset:18432
    s_waitcnt lgkmcnt(6)
    v_mfma_f32_32x32x16_bf16 v[144:159], v[204:207], v[76:79], v[144:159]
    v_exp_f32 v127, v127
    v_add_f32 v223, v223, v125
    v_add_f32 v223, v223, v126
    ds_read_b64_tr_b16 v[196:197], v217 offset:16384
    ds_read_b64_tr_b16 v[198:199], v217 offset:18432
    s_waitcnt lgkmcnt(7)
    v_mfma_f32_32x32x16_bf16 v[144:159], v[176:179], v[80:83], v[144:159]
    v_add_f32 v223, v223, v127
    v_cvt_pk_bf16_f32 v168, v112, v113
    v_cvt_pk_bf16_f32 v169, v114, v115
    ds_read_b64_tr_b16 v[200:201], v218 offset:16384
    ds_read_b64_tr_b16 v[202:203], v218 offset:18432
    s_waitcnt lgkmcnt(8)
    v_mfma_f32_32x32x16_bf16 v[144:159], v[180:183], v[84:87], v[144:159]
    v_cvt_pk_bf16_f32 v170, v116, v117
    v_cvt_pk_bf16_f32 v171, v118, v119
    v_cvt_pk_bf16_f32 v172, v120, v121
    v_cvt_pk_bf16_f32 v173, v122, v123
    ds_read_b64_tr_b16 v[204:205], v219 offset:16384
    ds_read_b64_tr_b16 v[206:207], v219 offset:18432
    s_waitcnt lgkmcnt(9)
    v_mfma_f32_32x32x16_bf16 v[144:159], v[184:187], v[88:91], v[144:159]
    v_cvt_pk_bf16_f32 v174, v124, v125
    v_cvt_pk_bf16_f32 v175, v126, v127
    v_add_f32 v222, v222, v223
    ds_read_b64_tr_b16 v[176:177], v216 offset:20480
    ds_read_b64_tr_b16 v[178:179], v216 offset:22528
    s_waitcnt lgkmcnt(10)
    v_mfma_f32_32x32x16_bf16 v[144:159], v[188:191], v[92:95], v[144:159]
    ds_read_b64_tr_b16 v[180:181], v217 offset:20480
    ds_read_b64_tr_b16 v[182:183], v217 offset:22528
    s_waitcnt lgkmcnt(10)
    v_mfma_f32_32x32x16_bf16 v[0:15], v[192:195], v[160:163], v[0:15]
    v_max3_f32 v225, v128, v129, v130
    v_max3_f32 v226, v131, v132, v133
    v_max3_f32 v225, v225, v134, v135
    ds_read_b64_tr_b16 v[184:185], v218 offset:20480
    ds_read_b64_tr_b16 v[186:187], v218 offset:22528
    s_waitcnt lgkmcnt(10)
    v_mfma_f32_32x32x16_bf16 v[16:31], v[196:199], v[160:163], v[16:31]
    v_max3_f32 v226, v226, v136, v137
    v_max3_f32 v225, v225, v138, v139
    v_max3_f32 v226, v226, v140, v141
    ds_read_b64_tr_b16 v[188:189], v219 offset:20480
    ds_read_b64_tr_b16 v[190:191], v219 offset:22528
    s_waitcnt lgkmcnt(10)
    v_mfma_f32_32x32x16_bf16 v[32:47], v[200:203], v[160:163], v[32:47]
    v_max3_f32 v225, v225, v142, v143
    v_max3_f32 v226, v226, v144, v145
    v_max3_f32 v225, v225, v146, v147
    v_max3_f32 v226, v226, v148, v149
    ds_read_b64_tr_b16 v[192:193], v216 offset:24576
    ds_read_b64_tr_b16 v[194:195], v216 offset:26624
    s_waitcnt lgkmcnt(10)
    v_mfma_f32_32x32x16_bf16 v[48:63], v[204:207], v[160:163], v[48:63]
    v_max3_f32 v225, v225, v150, v151
    v_max3_f32 v226, v226, v152, v153
    v_max3_f32 v225, v225, v154, v155
    ds_read_b64_tr_b16 v[196:197], v217 offset:24576
    ds_read_b64_tr_b16 v[198:199], v217 offset:26624
    s_waitcnt lgkmcnt(10)
    v_mfma_f32_32x32x16_bf16 v[0:15], v[176:179], v[164:167], v[0:15]
    v_max3_f32 v226, v226, v156, v157
    v_max3_f32 v225, v225, v158, v159
    v_max_f32 v225, v225, v226
    ds_read_b64_tr_b16 v[200:201], v218 offset:24576
    ds_read_b64_tr_b16 v[202:203], v218 offset:26624
    s_waitcnt lgkmcnt(10)
    v_mfma_f32_32x32x16_bf16 v[16:31], v[180:183], v[164:167], v[16:31]
    v_mov_b32 v226, v225
    s_nop 1
    v_permlane32_swap_b32 v225, v226
    v_max_f32 v225, v225, v226
    v_cmp_lt_f32 vcc, s41, v225
    s_cbranch_vccz Ldec11
    v_max_f32 v226, s49, v225
    v_sub_f32 v227, 0, v226
    v_min_f32 v227, 0, v227
    v_exp_f32 v224, v227
    v_sub_f32 v128, v128, v226
    v_sub_f32 v129, v129, v226
    v_sub_f32 v130, v130, v226
    v_sub_f32 v131, v131, v226
    v_sub_f32 v132, v132, v226
    v_sub_f32 v133, v133, v226
    v_sub_f32 v134, v134, v226
    v_sub_f32 v135, v135, v226
    v_sub_f32 v136, v136, v226
    v_sub_f32 v137, v137, v226
    v_sub_f32 v138, v138, v226
    v_sub_f32 v139, v139, v226
    v_sub_f32 v140, v140, v226
    v_sub_f32 v141, v141, v226
    v_sub_f32 v142, v142, v226
    v_sub_f32 v143, v143, v226
    v_sub_f32 v144, v144, v226
    v_sub_f32 v145, v145, v226
    v_sub_f32 v146, v146, v226
    v_sub_f32 v147, v147, v226
    v_sub_f32 v148, v148, v226
    v_sub_f32 v149, v149, v226
    v_sub_f32 v150, v150, v226
    v_sub_f32 v151, v151, v226
    v_sub_f32 v152, v152, v226
    v_sub_f32 v153, v153, v226
    v_sub_f32 v154, v154, v226
    v_sub_f32 v155, v155, v226
    v_sub_f32 v156, v156, v226
    v_sub_f32 v157, v157, v226
    v_sub_f32 v158, v158, v226
    v_sub_f32 v159, v159, v226
    v_sub_f32 v230, v230, v226
    v_sub_f32 v231, v231, v226
    v_sub_f32 v232, v232, v226
    v_sub_f32 v233, v233, v226
    v_sub_f32 v234, v234, v226
    v_sub_f32 v235, v235, v226
    v_sub_f32 v236, v236, v226
    v_sub_f32 v237, v237, v226
    v_sub_f32 v238, v238, v226
    v_sub_f32 v239, v239, v226
    v_sub_f32 v240, v240, v226
    v_sub_f32 v241, v241, v226
    v_sub_f32 v242, v242, v226
    v_sub_f32 v243, v243, v226
    v_sub_f32 v244, v244, v226
    v_sub_f32 v245, v245, v226
    s_mov_b32 s42, 1
    s_mov_b32 s41, 0x41000000
    s_mov_b32 s49, 0
Ldec11:
    ds_read_b64_tr_b16 v[204:205], v219 offset:24576
    ds_read_b64_tr_b16 v[206:207], v219 offset:26624
    s_waitcnt lgkmcnt(10)
    v_mfma_f32_32x32x16_bf16 v[32:47], v[184:187], v[164:167], v[32:47]
    v_exp_f32 v128, v128
    v_exp_f32 v129, v129
    v_exp_f32 v130, v130
    ds_read_b64_tr_b16 v[176:177], v216 offset:28672
    ds_read_b64_tr_b16 v[178:179], v216 offset:30720
    s_waitcnt lgkmcnt(10)
    v_mfma_f32_32x32x16_bf16 v[48:63], v[188:191], v[164:167], v[48:63]
    v_mov_b32 v223, v128
    v_exp_f32 v131, v131
    v_add_f32 v223, v223, v129
    ds_read_b64_tr_b16 v[180:181], v217 offset:28672
    ds_read_b64_tr_b16 v[182:183], v217 offset:30720
    s_waitcnt lgkmcnt(10)
    v_mfma_f32_32x32x16_bf16 v[0:15], v[192:195], v[168:171], v[0:15]
    v_exp_f32 v132, v132
    v_add_f32 v223, v223, v130
    v_exp_f32 v133, v133
    ds_read_b64_tr_b16 v[184:185], v218 offset:28672
    ds_read_b64_tr_b16 v[186:187], v218 offset:30720
    s_waitcnt lgkmcnt(10)
    v_mfma_f32_32x32x16_bf16 v[16:31], v[196:199], v[168:171], v[16:31]
    v_add_f32 v223, v223, v131
    v_exp_f32 v134, v134
    v_add_f32 v223, v223, v132
    ds_read_b64_tr_b16 v[188:189], v219 offset:28672
    ds_read_b64_tr_b16 v[190:191], v219 offset:30720
    s_waitcnt lgkmcnt(10)
    v_mfma_f32_32x32x16_bf16 v[32:47], v[200:203], v[168:171], v[32:47]
    v_exp_f32 v135, v135
    v_add_f32 v223, v223, v133
    v_exp_f32 v136, v136
    v_add_f32 v223, v223, v134
    s_waitcnt lgkmcnt(8)
    v_mfma_f32_32x32x16_bf16 v[48:63], v[204:207], v[168:171], v[48:63]
    v_exp_f32 v137, v137
    v_add_f32 v223, v223, v135
    v_exp_f32 v138, v138
    s_waitcnt vmcnt(8) lgkmcnt(0)
    s_barrier
    s_add_u32 m0, s37, 81920
    s_mov_b32 s54, 524544
    s_mov_b32 s55, 556288
    buffer_load_dwordx4 v228, s[12:15], s54 offen lds
    buffer_load_dwordx4 v228, s[12:15], s55 offen offset:1024 lds
    s_add_u32 m0, s37, 32768
    s_mov_b32 s54, 1048576
    s_mov_b32 s55, 1080320
    buffer_load_dwordx4 v228, s[12:15], s54 offen lds
    buffer_load_dwordx4 v228, s[12:15], s55 offen offset:1024 lds
    s_mov_b32 s55, 0
    s_and_b32 s54, s46, 3
    s_mul_i32 s54, s54, 576
    s_mul_i32 s53, s36, 72
    s_add_u32 s54, s54, s53
    v_add_u32 v221, s54, v249
    v_and_b32 v248, 3, v221
    v_lshrrev_b32 v221, 2, v221
    v_lshlrev_b32 v221, 13, v221
    v_lshl_add_u32 v221, v248, 7, v221
    v_add_u32 v221, s55, v221
    buffer_load_dword v220, v221, s[12:15], 0 offen
    v_add_u32 v221, s54, v249
    v_add_u32 v221, 64, v221
    v_and_b32 v248, 3, v221
    v_lshrrev_b32 v221, 2, v221
    v_lshlrev_b32 v221, 13, v221
    v_lshl_add_u32 v221, v248, 7, v221
    v_add_u32 v221, s55, v221
    v_cmp_lt_u32 vcc, 7, v249
    v_mov_b32 v248, 0x40000000
    s_nop 0
    v_cndmask_b32 v221, v221, v248, vcc
    buffer_load_dword v220, v221, s[12:15], 0 offen
    ds_read_b128 v[192:195], v208 offset:49152
    ds_read_b128 v[196:199], v209 offset:49152
    v_mfma_f32_32x32x16_bf16 v[0:15], v[176:179], v[172:175], v[0:15]
    v_add_f32 v223, v223, v136
    v_exp_f32 v139, v139
    v_add_f32 v223, v223, v137
    ds_read_b128 v[200:203], v210 offset:49152
    v_mfma_f32_32x32x16_bf16 v[16:31], v[180:183], v[172:175], v[16:31]
    v_exp_f32 v140, v140
    v_add_f32 v223, v223, v138
    v_exp_f32 v141, v141
    ds_read_b128 v[204:207], v211 offset:49152
    v_mfma_f32_32x32x16_bf16 v[32:47], v[184:187], v[172:175], v[32:47]
    v_add_f32 v223, v223, v139
    v_exp_f32 v142, v142
    v_add_f32 v223, v223, v140
    v_exp_f32 v143, v143
    ds_read_b128 v[176:179], v212 offset:49152
    v_mfma_f32_32x32x16_bf16 v[48:63], v[188:191], v[172:175], v[48:63]
    v_add_f32 v223, v223, v141
    v_add_f32 v223, v223, v142
    v_add_f32 v223, v223, v143
    ds_read_b128 v[180:183], v213 offset:49152
    s_waitcnt lgkmcnt(5)
    v_mfma_f32_32x32x16_bf16 v[96:111], v[192:195], v[64:67], v[230:245]
    s_cmp_eq_u32 s42, 0
    s_cbranch_scc1 Lrs12
    s_nop 15
    v_mul_f32 v0, v224, v0
    v_mul_f32 v1, v224, v1
    v_mul_f32 v2, v224, v2
    v_mul_f32 v3, v224, v3
    v_mul_f32 v4, v224, v4
    v_mul_f32 v5, v224, v5
    v_mul_f32 v6, v224, v6
    v_mul_f32 v7, v224, v7
    v_mul_f32 v8, v224, v8
    v_mul_f32 v9, v224, v9
    v_mul_f32 v10, v224, v10
    v_mul_f32 v11, v224, v11
    v_mul_f32 v12, v224, v12
    v_mul_f32 v13, v224, v13
    v_mul_f32 v14, v224, v14
    v_mul_f32 v15, v224, v15
    v_mul_f32 v16, v224, v16
    v_mul_f32 v17, v224, v17
    v_mul_f32 v18, v224, v18
    v_mul_f32 v19, v224, v19
    v_mul_f32 v20, v224, v20
    v_mul_f32 v21, v224, v21
    v_mul_f32 v22, v224, v22
    v_mul_f32 v23, v224, v23
    v_mul_f32 v24, v224, v24
    v_mul_f32 v25, v224, v25
    v_mul_f32 v26, v224, v26
    v_mul_f32 v27, v224, v27
    v_mul_f32 v28, v224, v28
    v_mul_f32 v29, v224, v29
    v_mul_f32 v30, v224, v30
    v_mul_f32 v31, v224, v31
    v_mul_f32 v32, v224, v32
    v_mul_f32 v33, v224, v33
    v_mul_f32 v34, v224, v34
    v_mul_f32 v35, v224, v35
    v_mul_f32 v36, v224, v36
    v_mul_f32 v37, v224, v37
    v_mul_f32 v38, v224, v38
    v_mul_f32 v39, v224, v39
    v_mul_f32 v40, v224, v40
    v_mul_f32 v41, v224, v41
    v_mul_f32 v42, v224, v42
    v_mul_f32 v43, v224, v43
    v_mul_f32 v44, v224, v44
    v_mul_f32 v45, v224, v45
    v_mul_f32 v46, v224, v46
    v_mul_f32 v47, v224, v47
    v_mul_f32 v48, v224, v48
    v_mul_f32 v49, v224, v49
    v_mul_f32 v50, v224, v50
    v_mul_f32 v51, v224, v51
    v_mul_f32 v52, v224, v52
    v_mul_f32 v53, v224, v53
    v_mul_f32 v54, v224, v54
    v_mul_f32 v55, v224, v55
    v_mul_f32 v56, v224, v56
    v_mul_f32 v57, v224, v57
    v_mul_f32 v58, v224, v58
    v_mul_f32 v59, v224, v59
    v_mul_f32 v60, v224, v60
    v_mul_f32 v61, v224, v61
    v_mul_f32 v62, v224, v62
    v_mul_f32 v63, v224, v63
    v_mul_f32 v222, v224, v222
    s_mov_b32 s42, 0
    s_nop 1
Lrs12:
    v_cvt_pk_bf16_f32 v160, v128, v129
    v_cvt_pk_bf16_f32 v161, v130, v131
    v_cvt_pk_bf16_f32 v162, v132, v133
    ds_read_b128 v[184:187], v214 offset:49152
    s_waitcnt lgkmcnt(5)
    v_mfma_f32_32x32x16_bf16 v[96:111], v[196:199], v[68:71], v[96:111]
    v_cvt_pk_bf16_f32 v163, v134, v135
    v_cvt_pk_bf16_f32 v164, v136, v137
    v_cvt_pk_bf16_f32 v165, v138, v139
    v_cvt_pk_bf16_f32 v166, v140, v141
    ds_read_b128 v[188:191], v215 offset:49152
    s_waitcnt lgkmcnt(5)
    v_mfma_f32_32x32x16_bf16 v[96:111], v[200:203], v[72:75], v[96:111]
    v_cvt_pk_bf16_f32 v167, v142, v143
    v_exp_f32 v144, v144
    v_exp_f32 v145, v145
    ds_read_b128 v[192:195], v208 offset:57344
    s_waitcnt lgkmcnt(5)
    v_mfma_f32_32x32x16_bf16 v[96:111], v[204:207], v[76:79], v[96:111]
    v_exp_f32 v146, v146
    v_add_f32 v223, v223, v144
    v_exp_f32 v147, v147
    ds_read_b128 v[196:199], v209 offset:57344
    s_waitcnt lgkmcnt(5)
    v_mfma_f32_32x32x16_bf16 v[96:111], v[176:179], v[80:83], v[96:111]
    v_add_f32 v223, v223, v145
    v_exp_f32 v148, v148
    v_add_f32 v223, v223, v146
    ds_read_b128 v[200:203], v210 offset:57344
    s_waitcnt lgkmcnt(5)
    v_mfma_f32_32x32x16_bf16 v[96:111], v[180:183], v[84:87], v[96:111]
    v_exp_f32 v149, v149
    v_add_f32 v223, v223, v147
    v_exp_f32 v150, v150
    v_add_f32 v223, v223, v148
    ds_read_b128 v[204:207], v211 offset:57344
    s_waitcnt lgkmcnt(5)
    v_mfma_f32_32x32x16_bf16 v[96:111], v[184:187], v[88:91], v[96:111]
    v_exp_f32 v151, v151
    v_add_f32 v223, v223, v149
    v_exp_f32 v152, v152
    ds_read_b128 v[176:179], v212 offset:57344
    s_waitcnt lgkmcnt(5)
    v_mfma_f32_32x32x16_bf16 v[96:111], v[188:191], v[92:95], v[96:111]
    v_add_f32 v223, v223, v150
    v_exp_f32 v153, v153
    v_add_f32 v223, v223, v151
    ds_read_b128 v[180:183], v213 offset:57344
    s_waitcnt lgkmcnt(5)
    v_mfma_f32_32x32x16_bf16 v[112:127], v[192:195], v[64:67], v[230:245]
    v_exp_f32 v154, v154
    v_add_f32 v223, v223, v152
    v_exp_f32 v155, v155
    ds_read_b128 v[184:187], v214 offset:57344
    s_waitcnt lgkmcnt(5)
    v_mfma_f32_32x32x16_bf16 v[112:127], v[196:199], v[68:71], v[112:127]
    v_add_f32 v223, v223, v153
    v_exp_f32 v156, v156
    v_add_f32 v223, v223, v154
    v_exp_f32 v157, v157
    ds_read_b128 v[188:191], v215 offset:57344
    s_waitcnt lgkmcnt(5)
    v_mfma_f32_32x32x16_bf16 v[112:127], v[200:203], v[72:75], v[112:127]
    v_add_f32 v223, v223, v155
    v_exp_f32 v158, v158
    v_add_f32 v223, v223, v156
    ds_read_b64_tr_b16 v[192:193], v216 offset:32768
    ds_read_b64_tr_b16 v[194:195], v216 offset:34816
    s_waitcnt lgkmcnt(6)
    v_mfma_f32_32x32x16_bf16 v[112:127], v[204:207], v[76:79], v[112:127]
    v_exp_f32 v159, v159
    v_add_f32 v223, v223, v157
    v_add_f32 v223, v223, v158
    ds_read_b64_tr_b16 v[196:197], v217 offset:32768
    ds_read_b64_tr_b16 v[198:199], v217 offset:34816
    s_waitcnt lgkmcnt(7)
    v_mfma_f32_32x32x16_bf16 v[112:127], v[176:179], v[80:83], v[112:127]
    v_add_f32 v223, v223, v159
    v_cvt_pk_bf16_f32 v168, v144, v145
    v_cvt_pk_bf16_f32 v169, v146, v147
    ds_read_b64_tr_b16 v[200:201], v218 offset:32768
    ds_read_b64_tr_b16 v[202:203], v218 offset:34816
    s_waitcnt lgkmcnt(8)
    v_mfma_f32_32x32x16_bf16 v[112:127], v[180:183], v[84:87], v[112:127]
    v_cvt_pk_bf16_f32 v170, v148, v149
    v_cvt_pk_bf16_f32 v171, v150, v151
    v_cvt_pk_bf16_f32 v172, v152, v153
    v_cvt_pk_bf16_f32 v173, v154, v155
    ds_read_b64_tr_b16 v[204:205], v219 offset:32768
    ds_read_b64_tr_b16 v[206:207], v219 offset:34816
    s_waitcnt lgkmcnt(9)
    v_mfma_f32_32x32x16_bf16 v[112:127], v[184:187], v[88:91], v[112:127]
    v_cvt_pk_bf16_f32 v174, v156, v157
    v_cvt_pk_bf16_f32 v175, v158, v159
    v_add_f32 v222, v222, v223
    ds_read_b64_tr_b16 v[176:177], v216 offset:36864
    ds_read_b64_tr_b16 v[178:179], v216 offset:38912
    s_waitcnt lgkmcnt(10)
    v_mfma_f32_32x32x16_bf16 v[112:127], v[188:191], v[92:95], v[112:127]
    ds_read_b64_tr_b16 v[180:181], v217 offset:36864
    ds_read_b64_tr_b16 v[182:183], v217 offset:38912
    s_waitcnt lgkmcnt(10)
    v_mfma_f32_32x32x16_bf16 v[0:15], v[192:195], v[160:163], v[0:15]
    v_max3_f32 v225, v96, v97, v98
    v_max3_f32 v226, v99, v100, v101
    v_max3_f32 v225, v225, v102, v103
    ds_read_b64_tr_b16 v[184:185], v218 offset:36864
    ds_read_b64_tr_b16 v[186:187], v218 offset:38912
    s_waitcnt lgkmcnt(10)
    v_mfma_f32_32x32x16_bf16 v[16:31], v[196:199], v[160:163], v[16:31]
    v_max3_f32 v226, v226, v104, v105
    v_max3_f32 v225, v225, v106, v107
    v_max3_f32 v226, v226, v108, v109
    ds_read_b64_tr_b16 v[188:189], v219 offset:36864
    ds_read_b64_tr_b16 v[190:191], v219 offset:38912
    s_waitcnt lgkmcnt(10)
    v_mfma_f32_32x32x16_bf16 v[32:47], v[200:203], v[160:163], v[32:47]
    v_max3_f32 v225, v225, v110, v111
    v_max3_f32 v226, v226, v112, v113
    v_max3_f32 v225, v225, v114, v115
    v_max3_f32 v226, v226, v116, v117
    ds_read_b64_tr_b16 v[192:193], v216 offset:40960
    ds_read_b64_tr_b16 v[194:195], v216 offset:43008
    s_waitcnt lgkmcnt(10)
    v_mfma_f32_32x32x16_bf16 v[48:63], v[204:207], v[160:163], v[48:63]
    v_max3_f32 v225, v225, v118, v119
    v_max3_f32 v226, v226, v120, v121
    v_max3_f32 v225, v225, v122, v123
    ds_read_b64_tr_b16 v[196:197], v217 offset:40960
    ds_read_b64_tr_b16 v[198:199], v217 offset:43008
    s_waitcnt lgkmcnt(10)
    v_mfma_f32_32x32x16_bf16 v[0:15], v[176:179], v[164:167], v[0:15]
    v_max3_f32 v226, v226, v124, v125
    v_max3_f32 v225, v225, v126, v127
    v_max_f32 v225, v225, v226
    ds_read_b64_tr_b16 v[200:201], v218 offset:40960
    ds_read_b64_tr_b16 v[202:203], v218 offset:43008
    s_waitcnt lgkmcnt(10)
    v_mfma_f32_32x32x16_bf16 v[16:31], v[180:183], v[164:167], v[16:31]
    v_mov_b32 v226, v225
    s_nop 1
    v_permlane32_swap_b32 v225, v226
    v_max_f32 v225, v225, v226
    v_cmp_lt_f32 vcc, s41, v225
    s_cbranch_vccz Ldec13
    v_max_f32 v226, s49, v225
    v_sub_f32 v227, 0, v226
    v_min_f32 v227, 0, v227
    v_exp_f32 v224, v227
    v_sub_f32 v96, v96, v226
    v_sub_f32 v97, v97, v226
    v_sub_f32 v98, v98, v226
    v_sub_f32 v99, v99, v226
    v_sub_f32 v100, v100, v226
    v_sub_f32 v101, v101, v226
    v_sub_f32 v102, v102, v226
    v_sub_f32 v103, v103, v226
    v_sub_f32 v104, v104, v226
    v_sub_f32 v105, v105, v226
    v_sub_f32 v106, v106, v226
    v_sub_f32 v107, v107, v226
    v_sub_f32 v108, v108, v226
    v_sub_f32 v109, v109, v226
    v_sub_f32 v110, v110, v226
    v_sub_f32 v111, v111, v226
    v_sub_f32 v112, v112, v226
    v_sub_f32 v113, v113, v226
    v_sub_f32 v114, v114, v226
    v_sub_f32 v115, v115, v226
    v_sub_f32 v116, v116, v226
    v_sub_f32 v117, v117, v226
    v_sub_f32 v118, v118, v226
    v_sub_f32 v119, v119, v226
    v_sub_f32 v120, v120, v226
    v_sub_f32 v121, v121, v226
    v_sub_f32 v122, v122, v226
    v_sub_f32 v123, v123, v226
    v_sub_f32 v124, v124, v226
    v_sub_f32 v125, v125, v226
    v_sub_f32 v126, v126, v226
    v_sub_f32 v127, v127, v226
    v_sub_f32 v230, v230, v226
    v_sub_f32 v231, v231, v226
    v_sub_f32 v232, v232, v226
    v_sub_f32 v233, v233, v226
    v_sub_f32 v234, v234, v226
    v_sub_f32 v235, v235, v226
    v_sub_f32 v236, v236, v226
    v_sub_f32 v237, v237, v226
    v_sub_f32 v238, v238, v226
    v_sub_f32 v239, v239, v226
    v_sub_f32 v240, v240, v226
    v_sub_f32 v241, v241, v226
    v_sub_f32 v242, v242, v226
    v_sub_f32 v243, v243, v226
    v_sub_f32 v244, v244, v226
    v_sub_f32 v245, v245, v226
    s_mov_b32 s42, 1
    s_mov_b32 s41, 0x41000000
    s_mov_b32 s49, 0
Ldec13:
    ds_read_b64_tr_b16 v[204:205], v219 offset:40960
    ds_read_b64_tr_b16 v[206:207], v219 offset:43008
    s_waitcnt lgkmcnt(10)
    v_mfma_f32_32x32x16_bf16 v[32:47], v[184:187], v[164:167], v[32:47]
    v_exp_f32 v96, v96
    v_exp_f32 v97, v97
    v_exp_f32 v98, v98
    ds_read_b64_tr_b16 v[176:177], v216 offset:45056
    ds_read_b64_tr_b16 v[178:179], v216 offset:47104
    s_waitcnt lgkmcnt(10)
    v_mfma_f32_32x32x16_bf16 v[48:63], v[188:191], v[164:167], v[48:63]
    v_mov_b32 v223, v96
    v_exp_f32 v99, v99
    v_add_f32 v223, v223, v97
    ds_read_b64_tr_b16 v[180:181], v217 offset:45056
    ds_read_b64_tr_b16 v[182:183], v217 offset:47104
    s_waitcnt lgkmcnt(10)
    v_mfma_f32_32x32x16_bf16 v[0:15], v[192:195], v[168:171], v[0:15]
    v_exp_f32 v100, v100
    v_add_f32 v223, v223, v98
    v_exp_f32 v101, v101
    ds_read_b64_tr_b16 v[184:185], v218 offset:45056
    ds_read_b64_tr_b16 v[186:187], v218 offset:47104
    s_waitcnt lgkmcnt(10)
    v_mfma_f32_32x32x16_bf16 v[16:31], v[196:199], v[168:171], v[16:31]
    v_add_f32 v223, v223, v99
    v_exp_f32 v102, v102
    v_add_f32 v223, v223, v100
    ds_read_b64_tr_b16 v[188:189], v219 offset:45056
    ds_read_b64_tr_b16 v[190:191], v219 offset:47104
    s_waitcnt lgkmcnt(10)
    v_mfma_f32_32x32x16_bf16 v[32:47], v[200:203], v[168:171], v[32:47]
    v_exp_f32 v103, v103
    v_add_f32 v223, v223, v101
    v_exp_f32 v104, v104
    v_add_f32 v223, v223, v102
    s_waitcnt lgkmcnt(8)
    v_mfma_f32_32x32x16_bf16 v[48:63], v[204:207], v[168:171], v[48:63]
    v_exp_f32 v105, v105
    v_add_f32 v223, v223, v103
    v_exp_f32 v106, v106
    s_waitcnt vmcnt(10) lgkmcnt(0)
    s_barrier
    s_add_u32 m0, s37, 131072
    s_mov_b32 s54, 0
    s_mov_b32 s55, 8192
    buffer_load_dwordx4 v229, s[8:11], s54 offen lds
    buffer_load_dwordx4 v253, s[8:11], s55 offen offset:1024 lds
    s_add_u32 m0, s37, 147456
    s_mov_b32 s54, 128
    s_mov_b32 s55, 8320
    buffer_load_dwordx4 v229, s[8:11], s54 offen lds
    buffer_load_dwordx4 v253, s[8:11], s55 offen offset:1024 lds
    ds_read_b128 v[192:195], v208 offset:0
    ds_read_b128 v[196:199], v209 offset:0
    v_mfma_f32_32x32x16_bf16 v[0:15], v[176:179], v[172:175], v[0:15]
    v_add_f32 v223, v223, v104
    v_exp_f32 v107, v107
    v_add_f32 v223, v223, v105
    ds_read_b128 v[200:203], v210 offset:0
    v_mfma_f32_32x32x16_bf16 v[16:31], v[180:183], v[172:175], v[16:31]
    v_exp_f32 v108, v108
    v_add_f32 v223, v223, v106
    v_exp_f32 v109, v109
    ds_read_b128 v[204:207], v211 offset:0
    v_mfma_f32_32x32x16_bf16 v[32:47], v[184:187], v[172:175], v[32:47]
    v_add_f32 v223, v223, v107
    v_exp_f32 v110, v110
    v_add_f32 v223, v223, v108
    v_exp_f32 v111, v111
    ds_read_b128 v[176:179], v212 offset:0
    v_mfma_f32_32x32x16_bf16 v[48:63], v[188:191], v[172:175], v[48:63]
    v_add_f32 v223, v223, v109
    v_add_f32 v223, v223, v110
    v_add_f32 v223, v223, v111
    ds_read_b128 v[180:183], v213 offset:0
    s_waitcnt lgkmcnt(5)
    v_mfma_f32_32x32x16_bf16 v[128:143], v[192:195], v[64:67], v[230:245]
    s_cmp_eq_u32 s42, 0
    s_cbranch_scc1 Lrs14
    s_nop 15
    v_mul_f32 v0, v224, v0
    v_mul_f32 v1, v224, v1
    v_mul_f32 v2, v224, v2
    v_mul_f32 v3, v224, v3
    v_mul_f32 v4, v224, v4
    v_mul_f32 v5, v224, v5
    v_mul_f32 v6, v224, v6
    v_mul_f32 v7, v224, v7
    v_mul_f32 v8, v224, v8
    v_mul_f32 v9, v224, v9
    v_mul_f32 v10, v224, v10
    v_mul_f32 v11, v224, v11
    v_mul_f32 v12, v224, v12
    v_mul_f32 v13, v224, v13
    v_mul_f32 v14, v224, v14
    v_mul_f32 v15, v224, v15
    v_mul_f32 v16, v224, v16
    v_mul_f32 v17, v224, v17
    v_mul_f32 v18, v224, v18
    v_mul_f32 v19, v224, v19
    v_mul_f32 v20, v224, v20
    v_mul_f32 v21, v224, v21
    v_mul_f32 v22, v224, v22
    v_mul_f32 v23, v224, v23
    v_mul_f32 v24, v224, v24
    v_mul_f32 v25, v224, v25
    v_mul_f32 v26, v224, v26
    v_mul_f32 v27, v224, v27
    v_mul_f32 v28, v224, v28
    v_mul_f32 v29, v224, v29
    v_mul_f32 v30, v224, v30
    v_mul_f32 v31, v224, v31
    v_mul_f32 v32, v224, v32
    v_mul_f32 v33, v224, v33
    v_mul_f32 v34, v224, v34
    v_mul_f32 v35, v224, v35
    v_mul_f32 v36, v224, v36
    v_mul_f32 v37, v224, v37
    v_mul_f32 v38, v224, v38
    v_mul_f32 v39, v224, v39
    v_mul_f32 v40, v224, v40
    v_mul_f32 v41, v224, v41
    v_mul_f32 v42, v224, v42
    v_mul_f32 v43, v224, v43
    v_mul_f32 v44, v224, v44
    v_mul_f32 v45, v224, v45
    v_mul_f32 v46, v224, v46
    v_mul_f32 v47, v224, v47
    v_mul_f32 v48, v224, v48
    v_mul_f32 v49, v224, v49
    v_mul_f32 v50, v224, v50
    v_mul_f32 v51, v224, v51
    v_mul_f32 v52, v224, v52
    v_mul_f32 v53, v224, v53
    v_mul_f32 v54, v224, v54
    v_mul_f32 v55, v224, v55
    v_mul_f32 v56, v224, v56
    v_mul_f32 v57, v224, v57
    v_mul_f32 v58, v224, v58
    v_mul_f32 v59, v224, v59
    v_mul_f32 v60, v224, v60
    v_mul_f32 v61, v224, v61
    v_mul_f32 v62, v224, v62
    v_mul_f32 v63, v224, v63
    v_mul_f32 v222, v224, v222
    s_mov_b32 s42, 0
    s_nop 1
Lrs14:
    v_cvt_pk_bf16_f32 v160, v96, v97
    v_cvt_pk_bf16_f32 v161, v98, v99
    v_cvt_pk_bf16_f32 v162, v100, v101
    ds_read_b128 v[184:187], v214 offset:0
    s_waitcnt lgkmcnt(5)
    v_mfma_f32_32x32x16_bf16 v[128:143], v[196:199], v[68:71], v[128:143]
    v_cvt_pk_bf16_f32 v163, v102, v103
    v_cvt_pk_bf16_f32 v164, v104, v105
    v_cvt_pk_bf16_f32 v165, v106, v107
    v_cvt_pk_bf16_f32 v166, v108, v109
    ds_read_b128 v[188:191], v215 offset:0
    s_waitcnt lgkmcnt(5)
    v_mfma_f32_32x32x16_bf16 v[128:143], v[200:203], v[72:75], v[128:143]
    v_cvt_pk_bf16_f32 v167, v110, v111
    v_exp_f32 v112, v112
    v_exp_f32 v113, v113
    ds_read_b128 v[192:195], v208 offset:8192
    s_waitcnt lgkmcnt(5)
    v_mfma_f32_32x32x16_bf16 v[128:143], v[204:207], v[76:79], v[128:143]
    v_exp_f32 v114, v114
    v_add_f32 v223, v223, v112
    v_exp_f32 v115, v115
    ds_read_b128 v[196:199], v209 offset:8192
    s_waitcnt lgkmcnt(5)
    v_mfma_f32_32x32x16_bf16 v[128:143], v[176:179], v[80:83], v[128:143]
    v_add_f32 v223, v223, v113
    v_exp_f32 v116, v116
    v_add_f32 v223, v223, v114
    ds_read_b128 v[200:203], v210 offset:8192
    s_waitcnt lgkmcnt(5)
    v_mfma_f32_32x32x16_bf16 v[128:143], v[180:183], v[84:87], v[128:143]
    v_exp_f32 v117, v117
    v_add_f32 v223, v223, v115
    v_exp_f32 v118, v118
    v_add_f32 v223, v223, v116
    ds_read_b128 v[204:207], v211 offset:8192
    s_waitcnt lgkmcnt(5)
    v_mfma_f32_32x32x16_bf16 v[128:143], v[184:187], v[88:91], v[128:143]
    v_exp_f32 v119, v119
    v_add_f32 v223, v223, v117
    v_exp_f32 v120, v120
    ds_read_b128 v[176:179], v212 offset:8192
    s_waitcnt lgkmcnt(5)
    v_mfma_f32_32x32x16_bf16 v[128:143], v[188:191], v[92:95], v[128:143]
    v_add_f32 v223, v223, v118
    v_exp_f32 v121, v121
    v_add_f32 v223, v223, v119
    ds_read_b128 v[180:183], v213 offset:8192
    s_waitcnt lgkmcnt(5)
    v_mfma_f32_32x32x16_bf16 v[144:159], v[192:195], v[64:67], v[230:245]
    v_exp_f32 v122, v122
    v_add_f32 v223, v223, v120
    v_exp_f32 v123, v123
    ds_read_b128 v[184:187], v214 offset:8192
    s_waitcnt lgkmcnt(5)
    v_mfma_f32_32x32x16_bf16 v[144:159], v[196:199], v[68:71], v[144:159]
    v_add_f32 v223, v223, v121
    v_exp_f32 v124, v124
    v_add_f32 v223, v223, v122
    v_exp_f32 v125, v125
    ds_read_b128 v[188:191], v215 offset:8192
    s_waitcnt lgkmcnt(5)
    v_mfma_f32_32x32x16_bf16 v[144:159], v[200:203], v[72:75], v[144:159]
    v_add_f32 v223, v223, v123
    v_exp_f32 v126, v126
    v_add_f32 v223, v223, v124
    ds_read_b64_tr_b16 v[192:193], v216 offset:49152
    ds_read_b64_tr_b16 v[194:195], v216 offset:51200
    s_waitcnt lgkmcnt(6)
    v_mfma_f32_32x32x16_bf16 v[144:159], v[204:207], v[76:79], v[144:159]
    v_exp_f32 v127, v127
    v_add_f32 v223, v223, v125
    v_add_f32 v223, v223, v126
    ds_read_b64_tr_b16 v[196:197], v217 offset:49152
    ds_read_b64_tr_b16 v[198:199], v217 offset:51200
    s_waitcnt lgkmcnt(7)
    v_mfma_f32_32x32x16_bf16 v[144:159], v[176:179], v[80:83], v[144:159]
    v_add_f32 v223, v223, v127
    v_cvt_pk_bf16_f32 v168, v112, v113
    v_cvt_pk_bf16_f32 v169, v114, v115
    ds_read_b64_tr_b16 v[200:201], v218 offset:49152
    ds_read_b64_tr_b16 v[202:203], v218 offset:51200
    s_waitcnt lgkmcnt(8)
    v_mfma_f32_32x32x16_bf16 v[144:159], v[180:183], v[84:87], v[144:159]
    v_cvt_pk_bf16_f32 v170, v116, v117
    v_cvt_pk_bf16_f32 v171, v118, v119
    v_cvt_pk_bf16_f32 v172, v120, v121
    v_cvt_pk_bf16_f32 v173, v122, v123
    ds_read_b64_tr_b16 v[204:205], v219 offset:49152
    ds_read_b64_tr_b16 v[206:207], v219 offset:51200
    s_waitcnt lgkmcnt(9)
    v_mfma_f32_32x32x16_bf16 v[144:159], v[184:187], v[88:91], v[144:159]
    v_cvt_pk_bf16_f32 v174, v124, v125
    v_cvt_pk_bf16_f32 v175, v126, v127
    v_add_f32 v222, v222, v223
    ds_read_b64_tr_b16 v[176:177], v216 offset:53248
    ds_read_b64_tr_b16 v[178:179], v216 offset:55296
    s_waitcnt lgkmcnt(10)
    v_mfma_f32_32x32x16_bf16 v[144:159], v[188:191], v[92:95], v[144:159]
    ds_read_b64_tr_b16 v[180:181], v217 offset:53248
    ds_read_b64_tr_b16 v[182:183], v217 offset:55296
    s_waitcnt lgkmcnt(10)
    v_mfma_f32_32x32x16_bf16 v[0:15], v[192:195], v[160:163], v[0:15]
    v_max3_f32 v225, v128, v129, v130
    v_max3_f32 v226, v131, v132, v133
    v_max3_f32 v225, v225, v134, v135
    ds_read_b64_tr_b16 v[184:185], v218 offset:53248
    ds_read_b64_tr_b16 v[186:187], v218 offset:55296
    s_waitcnt lgkmcnt(10)
    v_mfma_f32_32x32x16_bf16 v[16:31], v[196:199], v[160:163], v[16:31]
    v_max3_f32 v226, v226, v136, v137
    v_max3_f32 v225, v225, v138, v139
    v_max3_f32 v226, v226, v140, v141
    ds_read_b64_tr_b16 v[188:189], v219 offset:53248
    ds_read_b64_tr_b16 v[190:191], v219 offset:55296
    s_waitcnt lgkmcnt(10)
    v_mfma_f32_32x32x16_bf16 v[32:47], v[200:203], v[160:163], v[32:47]
    v_max3_f32 v225, v225, v142, v143
    v_max3_f32 v226, v226, v144, v145
    v_max3_f32 v225, v225, v146, v147
    v_max3_f32 v226, v226, v148, v149
    ds_read_b64_tr_b16 v[192:193], v216 offset:57344
    ds_read_b64_tr_b16 v[194:195], v216 offset:59392
    s_waitcnt lgkmcnt(10)
    v_mfma_f32_32x32x16_bf16 v[48:63], v[204:207], v[160:163], v[48:63]
    v_max3_f32 v225, v225, v150, v151
    v_max3_f32 v226, v226, v152, v153
    v_max3_f32 v225, v225, v154, v155
    ds_read_b64_tr_b16 v[196:197], v217 offset:57344
    ds_read_b64_tr_b16 v[198:199], v217 offset:59392
    s_waitcnt lgkmcnt(10)
    v_mfma_f32_32x32x16_bf16 v[0:15], v[176:179], v[164:167], v[0:15]
    v_max3_f32 v226, v226, v156, v157
    v_max3_f32 v225, v225, v158, v159
    v_max_f32 v225, v225, v226
    ds_read_b64_tr_b16 v[200:201], v218 offset:57344
    ds_read_b64_tr_b16 v[202:203], v218 offset:59392
    s_waitcnt lgkmcnt(10)
    v_mfma_f32_32x32x16_bf16 v[16:31], v[180:183], v[164:167], v[16:31]
    v_mov_b32 v226, v225
    s_nop 1
    v_permlane32_swap_b32 v225, v226
    v_max_f32 v225, v225, v226
    v_cmp_lt_f32 vcc, s41, v225
    s_cbranch_vccz Ldec15
    v_max_f32 v226, s49, v225
    v_sub_f32 v227, 0, v226
    v_min_f32 v227, 0, v227
    v_exp_f32 v224, v227
    v_sub_f32 v128, v128, v226
    v_sub_f32 v129, v129, v226
    v_sub_f32 v130, v130, v226
    v_sub_f32 v131, v131, v226
    v_sub_f32 v132, v132, v226
    v_sub_f32 v133, v133, v226
    v_sub_f32 v134, v134, v226
    v_sub_f32 v135, v135, v226
    v_sub_f32 v136, v136, v226
    v_sub_f32 v137, v137, v226
    v_sub_f32 v138, v138, v226
    v_sub_f32 v139, v139, v226
    v_sub_f32 v140, v140, v226
    v_sub_f32 v141, v141, v226
    v_sub_f32 v142, v142, v226
    v_sub_f32 v143, v143, v226
    v_sub_f32 v144, v144, v226
    v_sub_f32 v145, v145, v226
    v_sub_f32 v146, v146, v226
    v_sub_f32 v147, v147, v226
    v_sub_f32 v148, v148, v226
    v_sub_f32 v149, v149, v226
    v_sub_f32 v150, v150, v226
    v_sub_f32 v151, v151, v226
    v_sub_f32 v152, v152, v226
    v_sub_f32 v153, v153, v226
    v_sub_f32 v154, v154, v226
    v_sub_f32 v155, v155, v226
    v_sub_f32 v156, v156, v226
    v_sub_f32 v157, v157, v226
    v_sub_f32 v158, v158, v226
    v_sub_f32 v159, v159, v226
    v_sub_f32 v230, v230, v226
    v_sub_f32 v231, v231, v226
    v_sub_f32 v232, v232, v226
    v_sub_f32 v233, v233, v226
    v_sub_f32 v234, v234, v226
    v_sub_f32 v235, v235, v226
    v_sub_f32 v236, v236, v226
    v_sub_f32 v237, v237, v226
    v_sub_f32 v238, v238, v226
    v_sub_f32 v239, v239, v226
    v_sub_f32 v240, v240, v226
    v_sub_f32 v241, v241, v226
    v_sub_f32 v242, v242, v226
    v_sub_f32 v243, v243, v226
    v_sub_f32 v244, v244, v226
    v_sub_f32 v245, v245, v226
    s_mov_b32 s42, 1
    s_mov_b32 s41, 0x41000000
    s_mov_b32 s49, 0
Ldec15:
    ds_read_b64_tr_b16 v[204:205], v219 offset:57344
    ds_read_b64_tr_b16 v[206:207], v219 offset:59392
    s_waitcnt lgkmcnt(10)
    v_mfma_f32_32x32x16_bf16 v[32:47], v[184:187], v[164:167], v[32:47]
    v_exp_f32 v128, v128
    v_exp_f32 v129, v129
    v_exp_f32 v130, v130
    ds_read_b64_tr_b16 v[176:177], v216 offset:61440
    ds_read_b64_tr_b16 v[178:179], v216 offset:63488
    s_waitcnt lgkmcnt(10)
    v_mfma_f32_32x32x16_bf16 v[48:63], v[188:191], v[164:167], v[48:63]
    v_mov_b32 v223, v128
    v_exp_f32 v131, v131
    v_add_f32 v223, v223, v129
    ds_read_b64_tr_b16 v[180:181], v217 offset:61440
    ds_read_b64_tr_b16 v[182:183], v217 offset:63488
    s_waitcnt lgkmcnt(10)
    v_mfma_f32_32x32x16_bf16 v[0:15], v[192:195], v[168:171], v[0:15]
    v_exp_f32 v132, v132
    v_add_f32 v223, v223, v130
    v_exp_f32 v133, v133
    ds_read_b64_tr_b16 v[184:185], v218 offset:61440
    ds_read_b64_tr_b16 v[186:187], v218 offset:63488
    s_waitcnt lgkmcnt(10)
    v_mfma_f32_32x32x16_bf16 v[16:31], v[196:199], v[168:171], v[16:31]
    v_add_f32 v223, v223, v131
    v_exp_f32 v134, v134
    v_add_f32 v223, v223, v132
    ds_read_b64_tr_b16 v[188:189], v219 offset:61440
    ds_read_b64_tr_b16 v[190:191], v219 offset:63488
    s_waitcnt lgkmcnt(10)
    v_mfma_f32_32x32x16_bf16 v[32:47], v[200:203], v[168:171], v[32:47]
    v_exp_f32 v135, v135
    v_add_f32 v223, v223, v133
    v_exp_f32 v136, v136
    v_add_f32 v223, v223, v134
    s_waitcnt lgkmcnt(8)
    v_mfma_f32_32x32x16_bf16 v[48:63], v[204:207], v[168:171], v[48:63]
    v_exp_f32 v137, v137
    v_add_f32 v223, v223, v135
    v_exp_f32 v138, v138
    s_waitcnt vmcnt(12) lgkmcnt(0)
    s_barrier
    s_add_u32 m0, s37, 0
    s_mov_b32 s54, 0
    s_mov_b32 s55, 31744
    buffer_load_dwordx4 v228, s[12:15], s54 offen lds
    buffer_load_dwordx4 v228, s[12:15], s55 offen offset:1024 lds
    s_mov_b32 s50, s59
    v_lshrrev_b32 v250, 5, v249
    v_bfe_u32 v251, v249, 4, 1
    v_lshlrev_b32 v250, 2, v250
    v_add_u32 v250, v250, v251
    v_mul_u32_u24 v250, 4608, v250
    v_and_b32 v251, 15, v249
    v_lshl_add_u32 v250, v251, 1, v250
    v_add_u32 v251, 9216, v250
    s_lshr_b32 s51, s50, 1
    s_and_b32 s52, s50, 1
    s_mul_i32 s52, s52, 18
    s_mul_i32 s53, s51, 36864
    s_add_u32 s54, s36, 0
    s_min_u32 s54, s54, 17
    s_add_u32 s54, s54, s52
    s_lshl_b32 s55, s54, 5
    s_add_u32 s55, s55, s53
    buffer_load_ushort v96, v250, s[28:31], s55 offen offset:0
    buffer_load_ushort v97, v250, s[28:31], s55 offen offset:1152
    buffer_load_ushort v98, v250, s[28:31], s55 offen offset:2304
    buffer_load_ushort v99, v250, s[28:31], s55 offen offset:3456
    buffer_load_ushort v100, v251, s[28:31], s55 offen offset:0
    buffer_load_ushort v101, v251, s[28:31], s55 offen offset:1152
    buffer_load_ushort v102, v251, s[28:31], s55 offen offset:2304
    buffer_load_ushort v103, v251, s[28:31], s55 offen offset:3456
    s_mul_i32 s56, s51, 36
    s_add_u32 s56, s56, s54
    s_lshl_b32 s56, s56, 10
    s_add_u32 s54, s36, 8
    s_min_u32 s54, s54, 17
    s_add_u32 s54, s54, s52
    s_lshl_b32 s55, s54, 5
    s_add_u32 s55, s55, s53
    buffer_load_ushort v104, v250, s[28:31], s55 offen offset:0
    buffer_load_ushort v105, v250, s[28:31], s55 offen offset:1152
    buffer_load_ushort v106, v250, s[28:31], s55 offen offset:2304
    buffer_load_ushort v107, v250, s[28:31], s55 offen offset:3456
    buffer_load_ushort v108, v251, s[28:31], s55 offen offset:0
    buffer_load_ushort v109, v251, s[28:31], s55 offen offset:1152
    buffer_load_ushort v110, v251, s[28:31], s55 offen offset:2304
    buffer_load_ushort v111, v251, s[28:31], s55 offen offset:3456
    s_mul_i32 s57, s51, 36
    s_add_u32 s57, s57, s54
    s_lshl_b32 s57, s57, 10
    s_add_u32 s54, s36, 16
    s_min_u32 s54, s54, 17
    s_add_u32 s54, s54, s52
    s_lshl_b32 s55, s54, 5
    s_add_u32 s55, s55, s53
    buffer_load_ushort v112, v250, s[28:31], s55 offen offset:0
    buffer_load_ushort v113, v250, s[28:31], s55 offen offset:1152
    buffer_load_ushort v114, v250, s[28:31], s55 offen offset:2304
    buffer_load_ushort v115, v250, s[28:31], s55 offen offset:3456
    buffer_load_ushort v116, v251, s[28:31], s55 offen offset:0
    buffer_load_ushort v117, v251, s[28:31], s55 offen offset:1152
    buffer_load_ushort v118, v251, s[28:31], s55 offen offset:2304
    buffer_load_ushort v119, v251, s[28:31], s55 offen offset:3456
    s_mul_i32 s58, s51, 36
    s_add_u32 s58, s58, s54
    s_lshl_b32 s58, s58, 10
    ds_read_b64_tr_b16 v[192:193], v216 offset:0
    ds_read_b64_tr_b16 v[194:195], v216 offset:2048
    ds_read_b64_tr_b16 v[196:197], v217 offset:0
    ds_read_b64_tr_b16 v[198:199], v217 offset:2048
    v_mfma_f32_32x32x16_bf16 v[0:15], v[176:179], v[172:175], v[0:15]
    v_add_f32 v223, v223, v136
    v_exp_f32 v139, v139
    v_add_f32 v223, v223, v137
    ds_read_b64_tr_b16 v[200:201], v218 offset:0
    ds_read_b64_tr_b16 v[202:203], v218 offset:2048
    v_mfma_f32_32x32x16_bf16 v[16:31], v[180:183], v[172:175], v[16:31]
    v_exp_f32 v140, v140
    v_add_f32 v223, v223, v138
    v_exp_f32 v141, v141
    ds_read_b64_tr_b16 v[204:205], v219 offset:0
    ds_read_b64_tr_b16 v[206:207], v219 offset:2048
    v_mfma_f32_32x32x16_bf16 v[32:47], v[184:187], v[172:175], v[32:47]
    v_add_f32 v223, v223, v139
    v_exp_f32 v142, v142
    v_add_f32 v223, v223, v140
    v_exp_f32 v143, v143
    ds_read_b64_tr_b16 v[176:177], v216 offset:4096
    ds_read_b64_tr_b16 v[178:179], v216 offset:6144
    v_mfma_f32_32x32x16_bf16 v[48:63], v[188:191], v[172:175], v[48:63]
    v_add_f32 v223, v223, v141
    v_add_f32 v223, v223, v142
    v_add_f32 v223, v223, v143
    s_cmp_eq_u32 s42, 0
    s_cbranch_scc1 Lrs16
    s_nop 15
    v_mul_f32 v0, v224, v0
    v_mul_f32 v1, v224, v1
    v_mul_f32 v2, v224, v2
    v_mul_f32 v3, v224, v3
    v_mul_f32 v4, v224, v4
    v_mul_f32 v5, v224, v5
    v_mul_f32 v6, v224, v6
    v_mul_f32 v7, v224, v7
    v_mul_f32 v8, v224, v8
    v_mul_f32 v9, v224, v9
    v_mul_f32 v10, v224, v10
    v_mul_f32 v11, v224, v11
    v_mul_f32 v12, v224, v12
    v_mul_f32 v13, v224, v13
    v_mul_f32 v14, v224, v14
    v_mul_f32 v15, v224, v15
    v_mul_f32 v16, v224, v16
    v_mul_f32 v17, v224, v17
    v_mul_f32 v18, v224, v18
    v_mul_f32 v19, v224, v19
    v_mul_f32 v20, v224, v20
    v_mul_f32 v21, v224, v21
    v_mul_f32 v22, v224, v22
    v_mul_f32 v23, v224, v23
    v_mul_f32 v24, v224, v24
    v_mul_f32 v25, v224, v25
    v_mul_f32 v26, v224, v26
    v_mul_f32 v27, v224, v27
    v_mul_f32 v28, v224, v28
    v_mul_f32 v29, v224, v29
    v_mul_f32 v30, v224, v30
    v_mul_f32 v31, v224, v31
    v_mul_f32 v32, v224, v32
    v_mul_f32 v33, v224, v33
    v_mul_f32 v34, v224, v34
    v_mul_f32 v35, v224, v35
    v_mul_f32 v36, v224, v36
    v_mul_f32 v37, v224, v37
    v_mul_f32 v38, v224, v38
    v_mul_f32 v39, v224, v39
    v_mul_f32 v40, v224, v40
    v_mul_f32 v41, v224, v41
    v_mul_f32 v42, v224, v42
    v_mul_f32 v43, v224, v43
    v_mul_f32 v44, v224, v44
    v_mul_f32 v45, v224, v45
    v_mul_f32 v46, v224, v46
    v_mul_f32 v47, v224, v47
    v_mul_f32 v48, v224, v48
    v_mul_f32 v49, v224, v49
    v_mul_f32 v50, v224, v50
    v_mul_f32 v51, v224, v51
    v_mul_f32 v52, v224, v52
    v_mul_f32 v53, v224, v53
    v_mul_f32 v54, v224, v54
    v_mul_f32 v55, v224, v55
    v_mul_f32 v56, v224, v56
    v_mul_f32 v57, v224, v57
    v_mul_f32 v58, v224, v58
    v_mul_f32 v59, v224, v59
    v_mul_f32 v60, v224, v60
    v_mul_f32 v61, v224, v61
    v_mul_f32 v62, v224, v62
    v_mul_f32 v63, v224, v63
    v_mul_f32 v222, v224, v222
    s_mov_b32 s42, 0
    s_nop 1
Lrs16:
    v_cvt_pk_bf16_f32 v160, v128, v129
    v_cvt_pk_bf16_f32 v161, v130, v131
    v_cvt_pk_bf16_f32 v162, v132, v133
    v_cvt_pk_bf16_f32 v163, v134, v135
    v_cvt_pk_bf16_f32 v164, v136, v137
    v_cvt_pk_bf16_f32 v165, v138, v139
    v_cvt_pk_bf16_f32 v166, v140, v141
    v_cvt_pk_bf16_f32 v167, v142, v143
    v_exp_f32 v144, v144
    v_exp_f32 v145, v145
    v_exp_f32 v146, v146
    v_add_f32 v223, v223, v144
    v_exp_f32 v147, v147
    v_add_f32 v223, v223, v145
    v_exp_f32 v148, v148
    v_add_f32 v223, v223, v146
    v_exp_f32 v149, v149
    v_add_f32 v223, v223, v147
    v_exp_f32 v150, v150
    v_add_f32 v223, v223, v148
    v_exp_f32 v151, v151
    v_add_f32 v223, v223, v149
    v_exp_f32 v152, v152
    v_add_f32 v223, v223, v150
    v_exp_f32 v153, v153
    v_add_f32 v223, v223, v151
    v_exp_f32 v154, v154
    v_add_f32 v223, v223, v152
    v_exp_f32 v155, v155
    v_add_f32 v223, v223, v153
    v_exp_f32 v156, v156
    v_add_f32 v223, v223, v154
    v_exp_f32 v157, v157
    v_add_f32 v223, v223, v155
    v_exp_f32 v158, v158
    v_add_f32 v223, v223, v156
    v_exp_f32 v159, v159
    v_add_f32 v223, v223, v157
    v_add_f32 v223, v223, v158
    v_add_f32 v223, v223, v159
    v_cvt_pk_bf16_f32 v168, v144, v145
    v_cvt_pk_bf16_f32 v169, v146, v147
    v_cvt_pk_bf16_f32 v170, v148, v149
    v_cvt_pk_bf16_f32 v171, v150, v151
    v_cvt_pk_bf16_f32 v172, v152, v153
    v_cvt_pk_bf16_f32 v173, v154, v155
    v_cvt_pk_bf16_f32 v174, v156, v157
    v_cvt_pk_bf16_f32 v175, v158, v159
    v_add_f32 v222, v222, v223
    ds_read_b64_tr_b16 v[180:181], v217 offset:4096
    ds_read_b64_tr_b16 v[182:183], v217 offset:6144
    s_waitcnt lgkmcnt(10)
    v_mfma_f32_32x32x16_bf16 v[0:15], v[192:195], v[160:163], v[0:15]
    ds_read_b64_tr_b16 v[184:185], v218 offset:4096
    ds_read_b64_tr_b16 v[186:187], v218 offset:6144
    s_waitcnt lgkmcnt(10)
    v_mfma_f32_32x32x16_bf16 v[16:31], v[196:199], v[160:163], v[16:31]
    ds_read_b64_tr_b16 v[188:189], v219 offset:4096
    ds_read_b64_tr_b16 v[190:191], v219 offset:6144
    s_waitcnt lgkmcnt(10)
    v_mfma_f32_32x32x16_bf16 v[32:47], v[200:203], v[160:163], v[32:47]
    ds_read_b64_tr_b16 v[192:193], v216 offset:8192
    ds_read_b64_tr_b16 v[194:195], v216 offset:10240
    s_waitcnt lgkmcnt(10)
    v_mfma_f32_32x32x16_bf16 v[48:63], v[204:207], v[160:163], v[48:63]
    ds_read_b64_tr_b16 v[196:197], v217 offset:8192
    ds_read_b64_tr_b16 v[198:199], v217 offset:10240
    s_waitcnt lgkmcnt(10)
    v_mfma_f32_32x32x16_bf16 v[0:15], v[176:179], v[164:167], v[0:15]
    ds_read_b64_tr_b16 v[200:201], v218 offset:8192
    ds_read_b64_tr_b16 v[202:203], v218 offset:10240
    s_waitcnt lgkmcnt(10)
    v_mfma_f32_32x32x16_bf16 v[16:31], v[180:183], v[164:167], v[16:31]
    ds_read_b64_tr_b16 v[204:205], v219 offset:8192
    ds_read_b64_tr_b16 v[206:207], v219 offset:10240
    s_waitcnt lgkmcnt(10)
    v_mfma_f32_32x32x16_bf16 v[32:47], v[184:187], v[164:167], v[32:47]
    ds_read_b64_tr_b16 v[176:177], v216 offset:12288
    ds_read_b64_tr_b16 v[178:179], v216 offset:14336
    s_waitcnt lgkmcnt(10)
    v_mfma_f32_32x32x16_bf16 v[48:63], v[188:191], v[164:167], v[48:63]
    ds_read_b64_tr_b16 v[180:181], v217 offset:12288
    ds_read_b64_tr_b16 v[182:183], v217 offset:14336
    s_waitcnt lgkmcnt(10)
    v_mfma_f32_32x32x16_bf16 v[0:15], v[192:195], v[168:171], v[0:15]
    ds_read_b64_tr_b16 v[184:185], v218 offset:12288
    ds_read_b64_tr_b16 v[186:187], v218 offset:14336
    s_waitcnt lgkmcnt(10)
    v_mfma_f32_32x32x16_bf16 v[16:31], v[196:199], v[168:171], v[16:31]
    ds_read_b64_tr_b16 v[188:189], v219 offset:12288
    ds_read_b64_tr_b16 v[190:191], v219 offset:14336
    s_waitcnt lgkmcnt(10)
    v_mfma_f32_32x32x16_bf16 v[32:47], v[200:203], v[168:171], v[32:47]
    s_waitcnt lgkmcnt(8)
    v_mfma_f32_32x32x16_bf16 v[48:63], v[204:207], v[168:171], v[48:63]
    s_waitcnt lgkmcnt(6)
    v_mfma_f32_32x32x16_bf16 v[0:15], v[176:179], v[172:175], v[0:15]
    s_waitcnt lgkmcnt(4)
    v_mfma_f32_32x32x16_bf16 v[16:31], v[180:183], v[172:175], v[16:31]
    s_waitcnt lgkmcnt(2)
    v_mfma_f32_32x32x16_bf16 v[32:47], v[184:187], v[172:175], v[32:47]
    s_waitcnt lgkmcnt(0)
    v_mfma_f32_32x32x16_bf16 v[48:63], v[188:191], v[172:175], v[48:63]
    s_waitcnt lgkmcnt(0)
    s_barrier
    s_add_u32 m0, s37, 65536
    s_mov_b32 s54, 256
    s_mov_b32 s55, 32000
    buffer_load_dwordx4 v228, s[12:15], s54 offen lds
    buffer_load_dwordx4 v228, s[12:15], s55 offen offset:1024 lds
    v_mov_b32 v226, v222
    s_nop 1
    v_permlane32_swap_b32 v222, v226
    v_add_f32 v222, v222, v226
    v_rcp_f32 v222, v222
    v_bfe_u32 v248, v249, 4, 1
    v_lshrrev_b32 v250, 5, v249
    v_and_b32 v251, 15, v249
    v_lshlrev_b32 v251, 4, v251
    v_lshl_add_u32 v251, v250, 8, v251
    v_lshl_add_u32 v251, v248, 10, v251
    s_lshl_b32 s50, s46, 1
    s_lshr_b32 s51, s45, 1
    s_add_u32 s50, s50, s51
    s_lshl_b32 s50, s50, 19
    s_lshl_b32 s51, s47, 1
    s_add_u32 s51, s51, s44
    s_lshl_b32 s51, s51, 14
    s_add_u32 s50, s50, s51
    s_and_b32 s51, s45, 1
    s_lshl_b32 s51, s51, 11
    s_add_u32 s50, s50, s51
    v_mul_f32 v0, v222, v0
    v_mul_f32 v1, v222, v1
    v_mul_f32 v2, v222, v2
    v_mul_f32 v3, v222, v3
    v_mul_f32 v4, v222, v4
    v_mul_f32 v5, v222, v5
    v_mul_f32 v6, v222, v6
    v_mul_f32 v7, v222, v7
    v_mul_f32 v8, v222, v8
    v_mul_f32 v9, v222, v9
    v_mul_f32 v10, v222, v10
    v_mul_f32 v11, v222, v11
    v_mul_f32 v12, v222, v12
    v_mul_f32 v13, v222, v13
    v_mul_f32 v14, v222, v14
    v_mul_f32 v15, v222, v15
    v_cvt_pk_bf16_f32 v128, v0, v1
    v_cvt_pk_bf16_f32 v129, v2, v3
    v_cvt_pk_bf16_f32 v130, v4, v5
    v_cvt_pk_bf16_f32 v131, v6, v7
    v_cvt_pk_bf16_f32 v132, v8, v9
    v_cvt_pk_bf16_f32 v133, v10, v11
    v_cvt_pk_bf16_f32 v134, v12, v13
    v_cvt_pk_bf16_f32 v135, v14, v15
    v_mul_f32 v16, v222, v16
    v_mul_f32 v17, v222, v17
    v_mul_f32 v18, v222, v18
    v_mul_f32 v19, v222, v19
    v_mul_f32 v20, v222, v20
    v_mul_f32 v21, v222, v21
    v_mul_f32 v22, v222, v22
    v_mul_f32 v23, v222, v23
    v_mul_f32 v24, v222, v24
    v_mul_f32 v25, v222, v25
    v_mul_f32 v26, v222, v26
    v_mul_f32 v27, v222, v27
    v_mul_f32 v28, v222, v28
    v_mul_f32 v29, v222, v29
    v_mul_f32 v30, v222, v30
    v_mul_f32 v31, v222, v31
    v_cvt_pk_bf16_f32 v136, v16, v17
    v_cvt_pk_bf16_f32 v137, v18, v19
    v_cvt_pk_bf16_f32 v138, v20, v21
    v_cvt_pk_bf16_f32 v139, v22, v23
    v_cvt_pk_bf16_f32 v140, v24, v25
    v_cvt_pk_bf16_f32 v141, v26, v27
    v_cvt_pk_bf16_f32 v142, v28, v29
    v_cvt_pk_bf16_f32 v143, v30, v31
    v_mul_f32 v32, v222, v32
    v_mul_f32 v33, v222, v33
    v_mul_f32 v34, v222, v34
    v_mul_f32 v35, v222, v35
    v_mul_f32 v36, v222, v36
    v_mul_f32 v37, v222, v37
    v_mul_f32 v38, v222, v38
    v_mul_f32 v39, v222, v39
    v_mul_f32 v40, v222, v40
    v_mul_f32 v41, v222, v41
    v_mul_f32 v42, v222, v42
    v_mul_f32 v43, v222, v43
    v_mul_f32 v44, v222, v44
    v_mul_f32 v45, v222, v45
    v_mul_f32 v46, v222, v46
    v_mul_f32 v47, v222, v47
    v_cvt_pk_bf16_f32 v144, v32, v33
    v_cvt_pk_bf16_f32 v145, v34, v35
    v_cvt_pk_bf16_f32 v146, v36, v37
    v_cvt_pk_bf16_f32 v147, v38, v39
    v_cvt_pk_bf16_f32 v148, v40, v41
    v_cvt_pk_bf16_f32 v149, v42, v43
    v_cvt_pk_bf16_f32 v150, v44, v45
    v_cvt_pk_bf16_f32 v151, v46, v47
    v_mul_f32 v48, v222, v48
    v_mul_f32 v49, v222, v49
    v_mul_f32 v50, v222, v50
    v_mul_f32 v51, v222, v51
    v_mul_f32 v52, v222, v52
    v_mul_f32 v53, v222, v53
    v_mul_f32 v54, v222, v54
    v_mul_f32 v55, v222, v55
    v_mul_f32 v56, v222, v56
    v_mul_f32 v57, v222, v57
    v_mul_f32 v58, v222, v58
    v_mul_f32 v59, v222, v59
    v_mul_f32 v60, v222, v60
    v_mul_f32 v61, v222, v61
    v_mul_f32 v62, v222, v62
    v_mul_f32 v63, v222, v63
    v_cvt_pk_bf16_f32 v152, v48, v49
    v_cvt_pk_bf16_f32 v153, v50, v51
    v_cvt_pk_bf16_f32 v154, v52, v53
    v_cvt_pk_bf16_f32 v155, v54, v55
    v_cvt_pk_bf16_f32 v156, v56, v57
    v_cvt_pk_bf16_f32 v157, v58, v59
    v_cvt_pk_bf16_f32 v158, v60, v61
    v_cvt_pk_bf16_f32 v159, v62, v63
    s_waitcnt vmcnt(0)
    buffer_store_dwordx4 v[128:131], v251, s[24:27], s50 offen offset:0
    buffer_store_dwordx4 v[132:135], v251, s[24:27], s50 offen offset:512
    s_add_u32 s50, s50, 4096
    buffer_store_dwordx4 v[136:139], v251, s[24:27], s50 offen offset:0
    buffer_store_dwordx4 v[140:143], v251, s[24:27], s50 offen offset:512
    s_add_u32 s50, s50, 4096
    buffer_store_dwordx4 v[144:147], v251, s[24:27], s50 offen offset:0
    buffer_store_dwordx4 v[148:151], v251, s[24:27], s50 offen offset:512
    s_add_u32 s50, s50, 4096
    buffer_store_dwordx4 v[152:155], v251, s[24:27], s50 offen offset:0
    buffer_store_dwordx4 v[156:159], v251, s[24:27], s50 offen offset:512
    s_waitcnt vmcnt(8)
    v_lshlrev_b32 v248, 4, v249
    v_lshl_or_b32 v96, v97, 16, v96
    v_lshl_or_b32 v97, v99, 16, v98
    v_lshl_or_b32 v98, v101, 16, v100
    v_lshl_or_b32 v99, v103, 16, v102
    buffer_store_dwordx4 v[96:99], v248, s[32:35], s56 offen
    v_lshl_or_b32 v104, v105, 16, v104
    v_lshl_or_b32 v105, v107, 16, v106
    v_lshl_or_b32 v106, v109, 16, v108
    v_lshl_or_b32 v107, v111, 16, v110
    buffer_store_dwordx4 v[104:107], v248, s[32:35], s57 offen
    v_lshl_or_b32 v112, v113, 16, v112
    v_lshl_or_b32 v113, v115, 16, v114
    v_lshl_or_b32 v114, v117, 16, v116
    v_lshl_or_b32 v115, v119, 16, v118
    buffer_store_dwordx4 v[112:115], v248, s[32:35], s58 offen
    s_add_u32 s47, s47, 8
    s_add_u32 s4, s4, 1
    s_cmp_lt_u32 s4, 2
    s_cbranch_scc1 Lunit
Lattn_done:
    s_endpgm
.globl outproj_kernel
.p2align 8
.type outproj_kernel,@function
outproj_kernel:
    s_cmp_ge_u32 s2, 256
    s_cbranch_scc1 Lop_done
    s_load_dwordx2 s[4:5], s[0:1], 80
    s_load_dwordx2 s[6:7], s[0:1], 96
    s_and_b32 s28, s2, 7
    s_lshr_b32 s29, s2, 3
    s_lshr_b32 s21, s28, 2
    s_and_b32 s28, s28, 3
    s_lshl_b32 s28, s28, 3
    s_lshr_b32 s30, s29, 2
    s_add_u32 s22, s28, s30
    s_and_b32 s23, s29, 3
    v_lshrrev_b32 v1, 6, v0
    v_and_b32 v2, 63, v0
    v_readfirstlane_b32 s20, v1
    s_waitcnt lgkmcnt(0)
    s_lshl_b32 s28, s21, 24
    s_add_u32 s8, s6, s28
    s_addc_u32 s9, s7, 0
    s_and_b32 s9, s9, 0xffff
    s_mov_b32 s10, 16777216
    s_mov_b32 s11, 0x20000
    s_mul_i32 s28, s21, 4718592
    s_add_u32 s28, s28, 33554432
    s_add_u32 s12, s6, s28
    s_addc_u32 s13, s7, 0
    s_and_b32 s13, s13, 0xffff
    s_mov_b32 s14, 4718592
    s_mov_b32 s15, 0x20000
    s_mov_b32 s16, s4
    s_and_b32 s17, s5, 0xffff
    s_mov_b32 s18, 4718592
    s_mov_b32 s19, 0x20000
    s_lshl_b32 s28, s22, 7
    s_lshl_b32 s29, s20, 5
    s_add_u32 s28, s28, s29
    s_lshl_b32 s24, s28, 12
    s_mul_i32 s28, s29, 36
    s_mul_i32 s30, s23, 9
    s_add_u32 s28, s28, s30
    s_lshl_b32 s25, s28, 10
    v_lshlrev_b32 v4, 4, v2
    v_add_u32 v5, 0x1000, v4
    v_add_u32 v6, 0x2000, v4
    buffer_load_dwordx4 v[52:55], v4, s[8:11], s24 offen offset:0
    buffer_load_dwordx4 v[56:59], v4, s[8:11], s24 offen offset:1024
    buffer_load_dwordx4 v[60:63], v4, s[8:11], s24 offen offset:2048
    buffer_load_dwordx4 v[64:67], v4, s[8:11], s24 offen offset:3072
    buffer_load_dwordx4 v[16:19], v4, s[12:15], s25 offen offset:0
    buffer_load_dwordx4 v[20:23], v4, s[12:15], s25 offen offset:1024
    buffer_load_dwordx4 v[24:27], v4, s[12:15], s25 offen offset:2048
    buffer_load_dwordx4 v[28:31], v4, s[12:15], s25 offen offset:3072
    buffer_load_dwordx4 v[32:35], v5, s[12:15], s25 offen offset:0
    buffer_load_dwordx4 v[36:39], v5, s[12:15], s25 offen offset:1024
    buffer_load_dwordx4 v[40:43], v5, s[12:15], s25 offen offset:2048
    buffer_load_dwordx4 v[44:47], v5, s[12:15], s25 offen offset:3072
    buffer_load_dwordx4 v[48:51], v6, s[12:15], s25 offen offset:0
    s_add_u32 s24, s24, 4096
    s_add_u32 s25, s25, 36864
    buffer_load_dwordx4 v[104:107], v4, s[8:11], s24 offen offset:0
    buffer_load_dwordx4 v[108:111], v4, s[8:11], s24 offen offset:1024
    buffer_load_dwordx4 v[112:115], v4, s[8:11], s24 offen offset:2048
    buffer_load_dwordx4 v[116:119], v4, s[8:11], s24 offen offset:3072
    buffer_load_dwordx4 v[68:71], v4, s[12:15], s25 offen offset:0
    buffer_load_dwordx4 v[72:75], v4, s[12:15], s25 offen offset:1024
    buffer_load_dwordx4 v[76:79], v4, s[12:15], s25 offen offset:2048
    buffer_load_dwordx4 v[80:83], v4, s[12:15], s25 offen offset:3072
    buffer_load_dwordx4 v[84:87], v5, s[12:15], s25 offen offset:0
    buffer_load_dwordx4 v[88:91], v5, s[12:15], s25 offen offset:1024
    buffer_load_dwordx4 v[92:95], v5, s[12:15], s25 offen offset:2048
    buffer_load_dwordx4 v[96:99], v5, s[12:15], s25 offen offset:3072
    buffer_load_dwordx4 v[100:103], v6, s[12:15], s25 offen offset:0
    s_add_u32 s24, s24, 4096
    s_add_u32 s25, s25, 36864
    buffer_load_dwordx4 v[156:159], v4, s[8:11], s24 offen offset:0
    buffer_load_dwordx4 v[160:163], v4, s[8:11], s24 offen offset:1024
    buffer_load_dwordx4 v[164:167], v4, s[8:11], s24 offen offset:2048
    buffer_load_dwordx4 v[168:171], v4, s[8:11], s24 offen offset:3072
    buffer_load_dwordx4 v[120:123], v4, s[12:15], s25 offen offset:0
    buffer_load_dwordx4 v[124:127], v4, s[12:15], s25 offen offset:1024
    buffer_load_dwordx4 v[128:131], v4, s[12:15], s25 offen offset:2048
    buffer_load_dwordx4 v[132:135], v4, s[12:15], s25 offen offset:3072
    buffer_load_dwordx4 v[136:139], v5, s[12:15], s25 offen offset:0
    buffer_load_dwordx4 v[140:143], v5, s[12:15], s25 offen offset:1024
    buffer_load_dwordx4 v[144:147], v5, s[12:15], s25 offen offset:2048
    buffer_load_dwordx4 v[148:151], v5, s[12:15], s25 offen offset:3072
    buffer_load_dwordx4 v[152:155], v6, s[12:15], s25 offen offset:0
    s_add_u32 s24, s24, 4096
    s_add_u32 s25, s25, 36864
    buffer_load_dwordx4 v[208:211], v4, s[8:11], s24 offen offset:0
    buffer_load_dwordx4 v[212:215], v4, s[8:11], s24 offen offset:1024
    buffer_load_dwordx4 v[216:219], v4, s[8:11], s24 offen offset:2048
    buffer_load_dwordx4 v[220:223], v4, s[8:11], s24 offen offset:3072
    buffer_load_dwordx4 v[172:175], v4, s[12:15], s25 offen offset:0
    buffer_load_dwordx4 v[176:179], v4, s[12:15], s25 offen offset:1024
    buffer_load_dwordx4 v[180:183], v4, s[12:15], s25 offen offset:2048
    buffer_load_dwordx4 v[184:187], v4, s[12:15], s25 offen offset:3072
    buffer_load_dwordx4 v[188:191], v5, s[12:15], s25 offen offset:0
    buffer_load_dwordx4 v[192:195], v5, s[12:15], s25 offen offset:1024
    buffer_load_dwordx4 v[196:199], v5, s[12:15], s25 offen offset:2048
    buffer_load_dwordx4 v[200:203], v5, s[12:15], s25 offen offset:3072
    buffer_load_dwordx4 v[204:207], v6, s[12:15], s25 offen offset:0
    s_add_u32 s24, s24, 4096
    s_add_u32 s25, s25, 36864
    v_accvgpr_write_b32 a0, 0
    v_accvgpr_write_b32 a1, 0
    v_accvgpr_write_b32 a2, 0
    v_accvgpr_write_b32 a3, 0
    v_accvgpr_write_b32 a4, 0
    v_accvgpr_write_b32 a5, 0
    v_accvgpr_write_b32 a6, 0
    v_accvgpr_write_b32 a7, 0
    v_accvgpr_write_b32 a8, 0
    v_accvgpr_write_b32 a9, 0
    v_accvgpr_write_b32 a10, 0
    v_accvgpr_write_b32 a11, 0
    v_accvgpr_write_b32 a12, 0
    v_accvgpr_write_b32 a13, 0
    v_accvgpr_write_b32 a14, 0
    v_accvgpr_write_b32 a15, 0
    v_accvgpr_write_b32 a16, 0
    v_accvgpr_write_b32 a17, 0
    v_accvgpr_write_b32 a18, 0
    v_accvgpr_write_b32 a19, 0
    v_accvgpr_write_b32 a20, 0
    v_accvgpr_write_b32 a21, 0
    v_accvgpr_write_b32 a22, 0
    v_accvgpr_write_b32 a23, 0
    v_accvgpr_write_b32 a24, 0
    v_accvgpr_write_b32 a25, 0
    v_accvgpr_write_b32 a26, 0
    v_accvgpr_write_b32 a27, 0
    v_accvgpr_write_b32 a28, 0
    v_accvgpr_write_b32 a29, 0
    v_accvgpr_write_b32 a30, 0
    v_accvgpr_write_b32 a31, 0
    v_accvgpr_write_b32 a32, 0
    v_accvgpr_write_b32 a33, 0
    v_accvgpr_write_b32 a34, 0
    v_accvgpr_write_b32 a35, 0
    v_accvgpr_write_b32 a36, 0
    v_accvgpr_write_b32 a37, 0
    v_accvgpr_write_b32 a38, 0
    v_accvgpr_write_b32 a39, 0
    v_accvgpr_write_b32 a40, 0
    v_accvgpr_write_b32 a41, 0
    v_accvgpr_write_b32 a42, 0
    v_accvgpr_write_b32 a43, 0
    v_accvgpr_write_b32 a44, 0
    v_accvgpr_write_b32 a45, 0
    v_accvgpr_write_b32 a46, 0
    v_accvgpr_write_b32 a47, 0
    v_accvgpr_write_b32 a48, 0
    v_accvgpr_write_b32 a49, 0
    v_accvgpr_write_b32 a50, 0
    v_accvgpr_write_b32 a51, 0
    v_accvgpr_write_b32 a52, 0
    v_accvgpr_write_b32 a53, 0
    v_accvgpr_write_b32 a54, 0
    v_accvgpr_write_b32 a55, 0
    v_accvgpr_write_b32 a56, 0
    v_accvgpr_write_b32 a57, 0
    v_accvgpr_write_b32 a58, 0
    v_accvgpr_write_b32 a59, 0
    v_accvgpr_write_b32 a60, 0
    v_accvgpr_write_b32 a61, 0
    v_accvgpr_write_b32 a62, 0
    v_accvgpr_write_b32 a63, 0
    v_accvgpr_write_b32 a64, 0
    v_accvgpr_write_b32 a65, 0
    v_accvgpr_write_b32 a66, 0
    v_accvgpr_write_b32 a67, 0
    v_accvgpr_write_b32 a68, 0
    v_accvgpr_write_b32 a69, 0
    v_accvgpr_write_b32 a70, 0
    v_accvgpr_write_b32 a71, 0
    v_accvgpr_write_b32 a72, 0
    v_accvgpr_write_b32 a73, 0
    v_accvgpr_write_b32 a74, 0
    v_accvgpr_write_b32 a75, 0
    v_accvgpr_write_b32 a76, 0
    v_accvgpr_write_b32 a77, 0
    v_accvgpr_write_b32 a78, 0
    v_accvgpr_write_b32 a79, 0
    v_accvgpr_write_b32 a80, 0
    v_accvgpr_write_b32 a81, 0
    v_accvgpr_write_b32 a82, 0
    v_accvgpr_write_b32 a83, 0
    v_accvgpr_write_b32 a84, 0
    v_accvgpr_write_b32 a85, 0
    v_accvgpr_write_b32 a86, 0
    v_accvgpr_write_b32 a87, 0
    v_accvgpr_write_b32 a88, 0
    v_accvgpr_write_b32 a89, 0
    v_accvgpr_write_b32 a90, 0
    v_accvgpr_write_b32 a91, 0
    v_accvgpr_write_b32 a92, 0
    v_accvgpr_write_b32 a93, 0
    v_accvgpr_write_b32 a94, 0
    v_accvgpr_write_b32 a95, 0
    v_accvgpr_write_b32 a96, 0
    v_accvgpr_write_b32 a97, 0
    v_accvgpr_write_b32 a98, 0
    v_accvgpr_write_b32 a99, 0
    v_accvgpr_write_b32 a100, 0
    v_accvgpr_write_b32 a101, 0
    v_accvgpr_write_b32 a102, 0
    v_accvgpr_write_b32 a103, 0
    v_accvgpr_write_b32 a104, 0
    v_accvgpr_write_b32 a105, 0
    v_accvgpr_write_b32 a106, 0
    v_accvgpr_write_b32 a107, 0
    v_accvgpr_write_b32 a108, 0
    v_accvgpr_write_b32 a109, 0
    v_accvgpr_write_b32 a110, 0
    v_accvgpr_write_b32 a111, 0
    v_accvgpr_write_b32 a112, 0
    v_accvgpr_write_b32 a113, 0
    v_accvgpr_write_b32 a114, 0
    v_accvgpr_write_b32 a115, 0
    v_accvgpr_write_b32 a116, 0
    v_accvgpr_write_b32 a117, 0
    v_accvgpr_write_b32 a118, 0
    v_accvgpr_write_b32 a119, 0
    v_accvgpr_write_b32 a120, 0
    v_accvgpr_write_b32 a121, 0
    v_accvgpr_write_b32 a122, 0
    v_accvgpr_write_b32 a123, 0
    v_accvgpr_write_b32 a124, 0
    v_accvgpr_write_b32 a125, 0
    v_accvgpr_write_b32 a126, 0
    v_accvgpr_write_b32 a127, 0
    v_accvgpr_write_b32 a128, 0
    v_accvgpr_write_b32 a129, 0
    v_accvgpr_write_b32 a130, 0
    v_accvgpr_write_b32 a131, 0
    v_accvgpr_write_b32 a132, 0
    v_accvgpr_write_b32 a133, 0
    v_accvgpr_write_b32 a134, 0
    v_accvgpr_write_b32 a135, 0
    v_accvgpr_write_b32 a136, 0
    v_accvgpr_write_b32 a137, 0
    v_accvgpr_write_b32 a138, 0
    v_accvgpr_write_b32 a139, 0
    v_accvgpr_write_b32 a140, 0
    v_accvgpr_write_b32 a141, 0
    v_accvgpr_write_b32 a142, 0
    v_accvgpr_write_b32 a143, 0
    s_mov_b32 s26, 0
Lop_loop:
    s_waitcnt vmcnt(39)
    v_mfma_f32_16x16x32_bf16 a[0:3], v[16:19], v[52:55], a[0:3]
    v_mfma_f32_16x16x32_bf16 a[4:7], v[16:19], v[56:59], a[4:7]
    v_mfma_f32_16x16x32_bf16 a[8:11], v[16:19], v[60:63], a[8:11]
    v_mfma_f32_16x16x32_bf16 a[12:15], v[16:19], v[64:67], a[12:15]
    buffer_load_dwordx4 v[16:19], v4, s[12:15], s25 offen offset:0
    v_mfma_f32_16x16x32_bf16 a[16:19], v[20:23], v[52:55], a[16:19]
    v_mfma_f32_16x16x32_bf16 a[20:23], v[20:23], v[56:59], a[20:23]
    v_mfma_f32_16x16x32_bf16 a[24:27], v[20:23], v[60:63], a[24:27]
    v_mfma_f32_16x16x32_bf16 a[28:31], v[20:23], v[64:67], a[28:31]
    buffer_load_dwordx4 v[20:23], v4, s[12:15], s25 offen offset:1024
    v_mfma_f32_16x16x32_bf16 a[32:35], v[24:27], v[52:55], a[32:35]
    v_mfma_f32_16x16x32_bf16 a[36:39], v[24:27], v[56:59], a[36:39]
    v_mfma_f32_16x16x32_bf16 a[40:43], v[24:27], v[60:63], a[40:43]
    v_mfma_f32_16x16x32_bf16 a[44:47], v[24:27], v[64:67], a[44:47]
    buffer_load_dwordx4 v[24:27], v4, s[12:15], s25 offen offset:2048
    v_mfma_f32_16x16x32_bf16 a[48:51], v[28:31], v[52:55], a[48:51]
    v_mfma_f32_16x16x32_bf16 a[52:55], v[28:31], v[56:59], a[52:55]
    v_mfma_f32_16x16x32_bf16 a[56:59], v[28:31], v[60:63], a[56:59]
    v_mfma_f32_16x16x32_bf16 a[60:63], v[28:31], v[64:67], a[60:63]
    buffer_load_dwordx4 v[28:31], v4, s[12:15], s25 offen offset:3072
    v_mfma_f32_16x16x32_bf16 a[64:67], v[32:35], v[52:55], a[64:67]
    v_mfma_f32_16x16x32_bf16 a[68:71], v[32:35], v[56:59], a[68:71]
    v_mfma_f32_16x16x32_bf16 a[72:75], v[32:35], v[60:63], a[72:75]
    v_mfma_f32_16x16x32_bf16 a[76:79], v[32:35], v[64:67], a[76:79]
    buffer_load_dwordx4 v[32:35], v5, s[12:15], s25 offen offset:0
    v_mfma_f32_16x16x32_bf16 a[80:83], v[36:39], v[52:55], a[80:83]
    v_mfma_f32_16x16x32_bf16 a[84:87], v[36:39], v[56:59], a[84:87]
    v_mfma_f32_16x16x32_bf16 a[88:91], v[36:39], v[60:63], a[88:91]
    v_mfma_f32_16x16x32_bf16 a[92:95], v[36:39], v[64:67], a[92:95]
    buffer_load_dwordx4 v[36:39], v5, s[12:15], s25 offen offset:1024
    v_mfma_f32_16x16x32_bf16 a[96:99], v[40:43], v[52:55], a[96:99]
    v_mfma_f32_16x16x32_bf16 a[100:103], v[40:43], v[56:59], a[100:103]
    v_mfma_f32_16x16x32_bf16 a[104:107], v[40:43], v[60:63], a[104:107]
    v_mfma_f32_16x16x32_bf16 a[108:111], v[40:43], v[64:67], a[108:111]
    buffer_load_dwordx4 v[40:43], v5, s[12:15], s25 offen offset:2048
    v_mfma_f32_16x16x32_bf16 a[112:115], v[44:47], v[52:55], a[112:115]
    v_mfma_f32_16x16x32_bf16 a[116:119], v[44:47], v[56:59], a[116:119]
    v_mfma_f32_16x16x32_bf16 a[120:123], v[44:47], v[60:63], a[120:123]
    v_mfma_f32_16x16x32_bf16 a[124:127], v[44:47], v[64:67], a[124:127]
    buffer_load_dwordx4 v[44:47], v5, s[12:15], s25 offen offset:3072
    v_mfma_f32_16x16x32_bf16 a[128:131], v[48:51], v[52:55], a[128:131]
    v_mfma_f32_16x16x32_bf16 a[132:135], v[48:51], v[56:59], a[132:135]
    v_mfma_f32_16x16x32_bf16 a[136:139], v[48:51], v[60:63], a[136:139]
    v_mfma_f32_16x16x32_bf16 a[140:143], v[48:51], v[64:67], a[140:143]
    buffer_load_dwordx4 v[48:51], v6, s[12:15], s25 offen offset:0
    buffer_load_dwordx4 v[52:55], v4, s[8:11], s24 offen offset:0
    buffer_load_dwordx4 v[56:59], v4, s[8:11], s24 offen offset:1024
    buffer_load_dwordx4 v[60:63], v4, s[8:11], s24 offen offset:2048
    buffer_load_dwordx4 v[64:67], v4, s[8:11], s24 offen offset:3072
    s_add_u32 s24, s24, 4096
    s_add_u32 s25, s25, 36864
    s_waitcnt vmcnt(39)
    v_mfma_f32_16x16x32_bf16 a[0:3], v[68:71], v[104:107], a[0:3]
    v_mfma_f32_16x16x32_bf16 a[4:7], v[68:71], v[108:111], a[4:7]
    v_mfma_f32_16x16x32_bf16 a[8:11], v[68:71], v[112:115], a[8:11]
    v_mfma_f32_16x16x32_bf16 a[12:15], v[68:71], v[116:119], a[12:15]
    buffer_load_dwordx4 v[68:71], v4, s[12:15], s25 offen offset:0
    v_mfma_f32_16x16x32_bf16 a[16:19], v[72:75], v[104:107], a[16:19]
    v_mfma_f32_16x16x32_bf16 a[20:23], v[72:75], v[108:111], a[20:23]
    v_mfma_f32_16x16x32_bf16 a[24:27], v[72:75], v[112:115], a[24:27]
    v_mfma_f32_16x16x32_bf16 a[28:31], v[72:75], v[116:119], a[28:31]
    buffer_load_dwordx4 v[72:75], v4, s[12:15], s25 offen offset:1024
    v_mfma_f32_16x16x32_bf16 a[32:35], v[76:79], v[104:107], a[32:35]
    v_mfma_f32_16x16x32_bf16 a[36:39], v[76:79], v[108:111], a[36:39]
    v_mfma_f32_16x16x32_bf16 a[40:43], v[76:79], v[112:115], a[40:43]
    v_mfma_f32_16x16x32_bf16 a[44:47], v[76:79], v[116:119], a[44:47]
    buffer_load_dwordx4 v[76:79], v4, s[12:15], s25 offen offset:2048
    v_mfma_f32_16x16x32_bf16 a[48:51], v[80:83], v[104:107], a[48:51]
    v_mfma_f32_16x16x32_bf16 a[52:55], v[80:83], v[108:111], a[52:55]
    v_mfma_f32_16x16x32_bf16 a[56:59], v[80:83], v[112:115], a[56:59]
    v_mfma_f32_16x16x32_bf16 a[60:63], v[80:83], v[116:119], a[60:63]
    buffer_load_dwordx4 v[80:83], v4, s[12:15], s25 offen offset:3072
    v_mfma_f32_16x16x32_bf16 a[64:67], v[84:87], v[104:107], a[64:67]
    v_mfma_f32_16x16x32_bf16 a[68:71], v[84:87], v[108:111], a[68:71]
    v_mfma_f32_16x16x32_bf16 a[72:75], v[84:87], v[112:115], a[72:75]
    v_mfma_f32_16x16x32_bf16 a[76:79], v[84:87], v[116:119], a[76:79]
    buffer_load_dwordx4 v[84:87], v5, s[12:15], s25 offen offset:0
    v_mfma_f32_16x16x32_bf16 a[80:83], v[88:91], v[104:107], a[80:83]
    v_mfma_f32_16x16x32_bf16 a[84:87], v[88:91], v[108:111], a[84:87]
    v_mfma_f32_16x16x32_bf16 a[88:91], v[88:91], v[112:115], a[88:91]
    v_mfma_f32_16x16x32_bf16 a[92:95], v[88:91], v[116:119], a[92:95]
    buffer_load_dwordx4 v[88:91], v5, s[12:15], s25 offen offset:1024
    v_mfma_f32_16x16x32_bf16 a[96:99], v[92:95], v[104:107], a[96:99]
    v_mfma_f32_16x16x32_bf16 a[100:103], v[92:95], v[108:111], a[100:103]
    v_mfma_f32_16x16x32_bf16 a[104:107], v[92:95], v[112:115], a[104:107]
    v_mfma_f32_16x16x32_bf16 a[108:111], v[92:95], v[116:119], a[108:111]
    buffer_load_dwordx4 v[92:95], v5, s[12:15], s25 offen offset:2048
    v_mfma_f32_16x16x32_bf16 a[112:115], v[96:99], v[104:107], a[112:115]
    v_mfma_f32_16x16x32_bf16 a[116:119], v[96:99], v[108:111], a[116:119]
    v_mfma_f32_16x16x32_bf16 a[120:123], v[96:99], v[112:115], a[120:123]
    v_mfma_f32_16x16x32_bf16 a[124:127], v[96:99], v[116:119], a[124:127]
    buffer_load_dwordx4 v[96:99], v5, s[12:15], s25 offen offset:3072
    v_mfma_f32_16x16x32_bf16 a[128:131], v[100:103], v[104:107], a[128:131]
    v_mfma_f32_16x16x32_bf16 a[132:135], v[100:103], v[108:111], a[132:135]
    v_mfma_f32_16x16x32_bf16 a[136:139], v[100:103], v[112:115], a[136:139]
    v_mfma_f32_16x16x32_bf16 a[140:143], v[100:103], v[116:119], a[140:143]
    buffer_load_dwordx4 v[100:103], v6, s[12:15], s25 offen offset:0
    buffer_load_dwordx4 v[104:107], v4, s[8:11], s24 offen offset:0
    buffer_load_dwordx4 v[108:111], v4, s[8:11], s24 offen offset:1024
    buffer_load_dwordx4 v[112:115], v4, s[8:11], s24 offen offset:2048
    buffer_load_dwordx4 v[116:119], v4, s[8:11], s24 offen offset:3072
    s_add_u32 s24, s24, 4096
    s_add_u32 s25, s25, 36864
    s_waitcnt vmcnt(39)
    v_mfma_f32_16x16x32_bf16 a[0:3], v[120:123], v[156:159], a[0:3]
    v_mfma_f32_16x16x32_bf16 a[4:7], v[120:123], v[160:163], a[4:7]
    v_mfma_f32_16x16x32_bf16 a[8:11], v[120:123], v[164:167], a[8:11]
    v_mfma_f32_16x16x32_bf16 a[12:15], v[120:123], v[168:171], a[12:15]
    buffer_load_dwordx4 v[120:123], v4, s[12:15], s25 offen offset:0
    v_mfma_f32_16x16x32_bf16 a[16:19], v[124:127], v[156:159], a[16:19]
    v_mfma_f32_16x16x32_bf16 a[20:23], v[124:127], v[160:163], a[20:23]
    v_mfma_f32_16x16x32_bf16 a[24:27], v[124:127], v[164:167], a[24:27]
    v_mfma_f32_16x16x32_bf16 a[28:31], v[124:127], v[168:171], a[28:31]
    buffer_load_dwordx4 v[124:127], v4, s[12:15], s25 offen offset:1024
    v_mfma_f32_16x16x32_bf16 a[32:35], v[128:131], v[156:159], a[32:35]
    v_mfma_f32_16x16x32_bf16 a[36:39], v[128:131], v[160:163], a[36:39]
    v_mfma_f32_16x16x32_bf16 a[40:43], v[128:131], v[164:167], a[40:43]
    v_mfma_f32_16x16x32_bf16 a[44:47], v[128:131], v[168:171], a[44:47]
    buffer_load_dwordx4 v[128:131], v4, s[12:15], s25 offen offset:2048
    v_mfma_f32_16x16x32_bf16 a[48:51], v[132:135], v[156:159], a[48:51]
    v_mfma_f32_16x16x32_bf16 a[52:55], v[132:135], v[160:163], a[52:55]
    v_mfma_f32_16x16x32_bf16 a[56:59], v[132:135], v[164:167], a[56:59]
    v_mfma_f32_16x16x32_bf16 a[60:63], v[132:135], v[168:171], a[60:63]
    buffer_load_dwordx4 v[132:135], v4, s[12:15], s25 offen offset:3072
    v_mfma_f32_16x16x32_bf16 a[64:67], v[136:139], v[156:159], a[64:67]
    v_mfma_f32_16x16x32_bf16 a[68:71], v[136:139], v[160:163], a[68:71]
    v_mfma_f32_16x16x32_bf16 a[72:75], v[136:139], v[164:167], a[72:75]
    v_mfma_f32_16x16x32_bf16 a[76:79], v[136:139], v[168:171], a[76:79]
    buffer_load_dwordx4 v[136:139], v5, s[12:15], s25 offen offset:0
    v_mfma_f32_16x16x32_bf16 a[80:83], v[140:143], v[156:159], a[80:83]
    v_mfma_f32_16x16x32_bf16 a[84:87], v[140:143], v[160:163], a[84:87]
    v_mfma_f32_16x16x32_bf16 a[88:91], v[140:143], v[164:167], a[88:91]
    v_mfma_f32_16x16x32_bf16 a[92:95], v[140:143], v[168:171], a[92:95]
    buffer_load_dwordx4 v[140:143], v5, s[12:15], s25 offen offset:1024
    v_mfma_f32_16x16x32_bf16 a[96:99], v[144:147], v[156:159], a[96:99]
    v_mfma_f32_16x16x32_bf16 a[100:103], v[144:147], v[160:163], a[100:103]
    v_mfma_f32_16x16x32_bf16 a[104:107], v[144:147], v[164:167], a[104:107]
    v_mfma_f32_16x16x32_bf16 a[108:111], v[144:147], v[168:171], a[108:111]
    buffer_load_dwordx4 v[144:147], v5, s[12:15], s25 offen offset:2048
    v_mfma_f32_16x16x32_bf16 a[112:115], v[148:151], v[156:159], a[112:115]
    v_mfma_f32_16x16x32_bf16 a[116:119], v[148:151], v[160:163], a[116:119]
    v_mfma_f32_16x16x32_bf16 a[120:123], v[148:151], v[164:167], a[120:123]
    v_mfma_f32_16x16x32_bf16 a[124:127], v[148:151], v[168:171], a[124:127]
    buffer_load_dwordx4 v[148:151], v5, s[12:15], s25 offen offset:3072
    v_mfma_f32_16x16x32_bf16 a[128:131], v[152:155], v[156:159], a[128:131]
    v_mfma_f32_16x16x32_bf16 a[132:135], v[152:155], v[160:163], a[132:135]
    v_mfma_f32_16x16x32_bf16 a[136:139], v[152:155], v[164:167], a[136:139]
    v_mfma_f32_16x16x32_bf16 a[140:143], v[152:155], v[168:171], a[140:143]
    buffer_load_dwordx4 v[152:155], v6, s[12:15], s25 offen offset:0
    buffer_load_dwordx4 v[156:159], v4, s[8:11], s24 offen offset:0
    buffer_load_dwordx4 v[160:163], v4, s[8:11], s24 offen offset:1024
    buffer_load_dwordx4 v[164:167], v4, s[8:11], s24 offen offset:2048
    buffer_load_dwordx4 v[168:171], v4, s[8:11], s24 offen offset:3072
    s_add_u32 s24, s24, 4096
    s_add_u32 s25, s25, 36864
    s_waitcnt vmcnt(39)
    v_mfma_f32_16x16x32_bf16 a[0:3], v[172:175], v[208:211], a[0:3]
    v_mfma_f32_16x16x32_bf16 a[4:7], v[172:175], v[212:215], a[4:7]
    v_mfma_f32_16x16x32_bf16 a[8:11], v[172:175], v[216:219], a[8:11]
    v_mfma_f32_16x16x32_bf16 a[12:15], v[172:175], v[220:223], a[12:15]
    buffer_load_dwordx4 v[172:175], v4, s[12:15], s25 offen offset:0
    v_mfma_f32_16x16x32_bf16 a[16:19], v[176:179], v[208:211], a[16:19]
    v_mfma_f32_16x16x32_bf16 a[20:23], v[176:179], v[212:215], a[20:23]
    v_mfma_f32_16x16x32_bf16 a[24:27], v[176:179], v[216:219], a[24:27]
    v_mfma_f32_16x16x32_bf16 a[28:31], v[176:179], v[220:223], a[28:31]
    buffer_load_dwordx4 v[176:179], v4, s[12:15], s25 offen offset:1024
    v_mfma_f32_16x16x32_bf16 a[32:35], v[180:183], v[208:211], a[32:35]
    v_mfma_f32_16x16x32_bf16 a[36:39], v[180:183], v[212:215], a[36:39]
    v_mfma_f32_16x16x32_bf16 a[40:43], v[180:183], v[216:219], a[40:43]
    v_mfma_f32_16x16x32_bf16 a[44:47], v[180:183], v[220:223], a[44:47]
    buffer_load_dwordx4 v[180:183], v4, s[12:15], s25 offen offset:2048
    v_mfma_f32_16x16x32_bf16 a[48:51], v[184:187], v[208:211], a[48:51]
    v_mfma_f32_16x16x32_bf16 a[52:55], v[184:187], v[212:215], a[52:55]
    v_mfma_f32_16x16x32_bf16 a[56:59], v[184:187], v[216:219], a[56:59]
    v_mfma_f32_16x16x32_bf16 a[60:63], v[184:187], v[220:223], a[60:63]
    buffer_load_dwordx4 v[184:187], v4, s[12:15], s25 offen offset:3072
    v_mfma_f32_16x16x32_bf16 a[64:67], v[188:191], v[208:211], a[64:67]
    v_mfma_f32_16x16x32_bf16 a[68:71], v[188:191], v[212:215], a[68:71]
    v_mfma_f32_16x16x32_bf16 a[72:75], v[188:191], v[216:219], a[72:75]
    v_mfma_f32_16x16x32_bf16 a[76:79], v[188:191], v[220:223], a[76:79]
    buffer_load_dwordx4 v[188:191], v5, s[12:15], s25 offen offset:0
    v_mfma_f32_16x16x32_bf16 a[80:83], v[192:195], v[208:211], a[80:83]
    v_mfma_f32_16x16x32_bf16 a[84:87], v[192:195], v[212:215], a[84:87]
    v_mfma_f32_16x16x32_bf16 a[88:91], v[192:195], v[216:219], a[88:91]
    v_mfma_f32_16x16x32_bf16 a[92:95], v[192:195], v[220:223], a[92:95]
    buffer_load_dwordx4 v[192:195], v5, s[12:15], s25 offen offset:1024
    v_mfma_f32_16x16x32_bf16 a[96:99], v[196:199], v[208:211], a[96:99]
    v_mfma_f32_16x16x32_bf16 a[100:103], v[196:199], v[212:215], a[100:103]
    v_mfma_f32_16x16x32_bf16 a[104:107], v[196:199], v[216:219], a[104:107]
    v_mfma_f32_16x16x32_bf16 a[108:111], v[196:199], v[220:223], a[108:111]
    buffer_load_dwordx4 v[196:199], v5, s[12:15], s25 offen offset:2048
    v_mfma_f32_16x16x32_bf16 a[112:115], v[200:203], v[208:211], a[112:115]
    v_mfma_f32_16x16x32_bf16 a[116:119], v[200:203], v[212:215], a[116:119]
    v_mfma_f32_16x16x32_bf16 a[120:123], v[200:203], v[216:219], a[120:123]
    v_mfma_f32_16x16x32_bf16 a[124:127], v[200:203], v[220:223], a[124:127]
    buffer_load_dwordx4 v[200:203], v5, s[12:15], s25 offen offset:3072
    v_mfma_f32_16x16x32_bf16 a[128:131], v[204:207], v[208:211], a[128:131]
    v_mfma_f32_16x16x32_bf16 a[132:135], v[204:207], v[212:215], a[132:135]
    v_mfma_f32_16x16x32_bf16 a[136:139], v[204:207], v[216:219], a[136:139]
    v_mfma_f32_16x16x32_bf16 a[140:143], v[204:207], v[220:223], a[140:143]
    buffer_load_dwordx4 v[204:207], v6, s[12:15], s25 offen offset:0
    buffer_load_dwordx4 v[208:211], v4, s[8:11], s24 offen offset:0
    buffer_load_dwordx4 v[212:215], v4, s[8:11], s24 offen offset:1024
    buffer_load_dwordx4 v[216:219], v4, s[8:11], s24 offen offset:2048
    buffer_load_dwordx4 v[220:223], v4, s[8:11], s24 offen offset:3072
    s_add_u32 s24, s24, 4096
    s_add_u32 s25, s25, 36864
    s_add_u32 s26, s26, 1
    s_cmp_lt_u32 s26, 7
    s_cbranch_scc1 Lop_loop
    s_waitcnt vmcnt(39)
    v_mfma_f32_16x16x32_bf16 a[0:3], v[16:19], v[52:55], a[0:3]
    v_mfma_f32_16x16x32_bf16 a[4:7], v[16:19], v[56:59], a[4:7]
    v_mfma_f32_16x16x32_bf16 a[8:11], v[16:19], v[60:63], a[8:11]
    v_mfma_f32_16x16x32_bf16 a[12:15], v[16:19], v[64:67], a[12:15]
    v_mfma_f32_16x16x32_bf16 a[16:19], v[20:23], v[52:55], a[16:19]
    v_mfma_f32_16x16x32_bf16 a[20:23], v[20:23], v[56:59], a[20:23]
    v_mfma_f32_16x16x32_bf16 a[24:27], v[20:23], v[60:63], a[24:27]
    v_mfma_f32_16x16x32_bf16 a[28:31], v[20:23], v[64:67], a[28:31]
    v_mfma_f32_16x16x32_bf16 a[32:35], v[24:27], v[52:55], a[32:35]
    v_mfma_f32_16x16x32_bf16 a[36:39], v[24:27], v[56:59], a[36:39]
    v_mfma_f32_16x16x32_bf16 a[40:43], v[24:27], v[60:63], a[40:43]
    v_mfma_f32_16x16x32_bf16 a[44:47], v[24:27], v[64:67], a[44:47]
    v_mfma_f32_16x16x32_bf16 a[48:51], v[28:31], v[52:55], a[48:51]
    v_mfma_f32_16x16x32_bf16 a[52:55], v[28:31], v[56:59], a[52:55]
    v_mfma_f32_16x16x32_bf16 a[56:59], v[28:31], v[60:63], a[56:59]
    v_mfma_f32_16x16x32_bf16 a[60:63], v[28:31], v[64:67], a[60:63]
    v_mfma_f32_16x16x32_bf16 a[64:67], v[32:35], v[52:55], a[64:67]
    v_mfma_f32_16x16x32_bf16 a[68:71], v[32:35], v[56:59], a[68:71]
    v_mfma_f32_16x16x32_bf16 a[72:75], v[32:35], v[60:63], a[72:75]
    v_mfma_f32_16x16x32_bf16 a[76:79], v[32:35], v[64:67], a[76:79]
    v_mfma_f32_16x16x32_bf16 a[80:83], v[36:39], v[52:55], a[80:83]
    v_mfma_f32_16x16x32_bf16 a[84:87], v[36:39], v[56:59], a[84:87]
    v_mfma_f32_16x16x32_bf16 a[88:91], v[36:39], v[60:63], a[88:91]
    v_mfma_f32_16x16x32_bf16 a[92:95], v[36:39], v[64:67], a[92:95]
    v_mfma_f32_16x16x32_bf16 a[96:99], v[40:43], v[52:55], a[96:99]
    v_mfma_f32_16x16x32_bf16 a[100:103], v[40:43], v[56:59], a[100:103]
    v_mfma_f32_16x16x32_bf16 a[104:107], v[40:43], v[60:63], a[104:107]
    v_mfma_f32_16x16x32_bf16 a[108:111], v[40:43], v[64:67], a[108:111]
    v_mfma_f32_16x16x32_bf16 a[112:115], v[44:47], v[52:55], a[112:115]
    v_mfma_f32_16x16x32_bf16 a[116:119], v[44:47], v[56:59], a[116:119]
    v_mfma_f32_16x16x32_bf16 a[120:123], v[44:47], v[60:63], a[120:123]
    v_mfma_f32_16x16x32_bf16 a[124:127], v[44:47], v[64:67], a[124:127]
    v_mfma_f32_16x16x32_bf16 a[128:131], v[48:51], v[52:55], a[128:131]
    v_mfma_f32_16x16x32_bf16 a[132:135], v[48:51], v[56:59], a[132:135]
    v_mfma_f32_16x16x32_bf16 a[136:139], v[48:51], v[60:63], a[136:139]
    v_mfma_f32_16x16x32_bf16 a[140:143], v[48:51], v[64:67], a[140:143]
    s_waitcnt vmcnt(26)
    v_mfma_f32_16x16x32_bf16 a[0:3], v[68:71], v[104:107], a[0:3]
    v_mfma_f32_16x16x32_bf16 a[4:7], v[68:71], v[108:111], a[4:7]
    v_mfma_f32_16x16x32_bf16 a[8:11], v[68:71], v[112:115], a[8:11]
    v_mfma_f32_16x16x32_bf16 a[12:15], v[68:71], v[116:119], a[12:15]
    v_mfma_f32_16x16x32_bf16 a[16:19], v[72:75], v[104:107], a[16:19]
    v_mfma_f32_16x16x32_bf16 a[20:23], v[72:75], v[108:111], a[20:23]
    v_mfma_f32_16x16x32_bf16 a[24:27], v[72:75], v[112:115], a[24:27]
    v_mfma_f32_16x16x32_bf16 a[28:31], v[72:75], v[116:119], a[28:31]
    v_mfma_f32_16x16x32_bf16 a[32:35], v[76:79], v[104:107], a[32:35]
    v_mfma_f32_16x16x32_bf16 a[36:39], v[76:79], v[108:111], a[36:39]
    v_mfma_f32_16x16x32_bf16 a[40:43], v[76:79], v[112:115], a[40:43]
    v_mfma_f32_16x16x32_bf16 a[44:47], v[76:79], v[116:119], a[44:47]
    v_mfma_f32_16x16x32_bf16 a[48:51], v[80:83], v[104:107], a[48:51]
    v_mfma_f32_16x16x32_bf16 a[52:55], v[80:83], v[108:111], a[52:55]
    v_mfma_f32_16x16x32_bf16 a[56:59], v[80:83], v[112:115], a[56:59]
    v_mfma_f32_16x16x32_bf16 a[60:63], v[80:83], v[116:119], a[60:63]
    v_mfma_f32_16x16x32_bf16 a[64:67], v[84:87], v[104:107], a[64:67]
    v_mfma_f32_16x16x32_bf16 a[68:71], v[84:87], v[108:111], a[68:71]
    v_mfma_f32_16x16x32_bf16 a[72:75], v[84:87], v[112:115], a[72:75]
    v_mfma_f32_16x16x32_bf16 a[76:79], v[84:87], v[116:119], a[76:79]
    v_mfma_f32_16x16x32_bf16 a[80:83], v[88:91], v[104:107], a[80:83]
    v_mfma_f32_16x16x32_bf16 a[84:87], v[88:91], v[108:111], a[84:87]
    v_mfma_f32_16x16x32_bf16 a[88:91], v[88:91], v[112:115], a[88:91]
    v_mfma_f32_16x16x32_bf16 a[92:95], v[88:91], v[116:119], a[92:95]
    v_mfma_f32_16x16x32_bf16 a[96:99], v[92:95], v[104:107], a[96:99]
    v_mfma_f32_16x16x32_bf16 a[100:103], v[92:95], v[108:111], a[100:103]
    v_mfma_f32_16x16x32_bf16 a[104:107], v[92:95], v[112:115], a[104:107]
    v_mfma_f32_16x16x32_bf16 a[108:111], v[92:95], v[116:119], a[108:111]
    v_mfma_f32_16x16x32_bf16 a[112:115], v[96:99], v[104:107], a[112:115]
    v_mfma_f32_16x16x32_bf16 a[116:119], v[96:99], v[108:111], a[116:119]
    v_mfma_f32_16x16x32_bf16 a[120:123], v[96:99], v[112:115], a[120:123]
    v_mfma_f32_16x16x32_bf16 a[124:127], v[96:99], v[116:119], a[124:127]
    v_mfma_f32_16x16x32_bf16 a[128:131], v[100:103], v[104:107], a[128:131]
    v_mfma_f32_16x16x32_bf16 a[132:135], v[100:103], v[108:111], a[132:135]
    v_mfma_f32_16x16x32_bf16 a[136:139], v[100:103], v[112:115], a[136:139]
    v_mfma_f32_16x16x32_bf16 a[140:143], v[100:103], v[116:119], a[140:143]
    s_waitcnt vmcnt(13)
    v_mfma_f32_16x16x32_bf16 a[0:3], v[120:123], v[156:159], a[0:3]
    v_mfma_f32_16x16x32_bf16 a[4:7], v[120:123], v[160:163], a[4:7]
    v_mfma_f32_16x16x32_bf16 a[8:11], v[120:123], v[164:167], a[8:11]
    v_mfma_f32_16x16x32_bf16 a[12:15], v[120:123], v[168:171], a[12:15]
    v_mfma_f32_16x16x32_bf16 a[16:19], v[124:127], v[156:159], a[16:19]
    v_mfma_f32_16x16x32_bf16 a[20:23], v[124:127], v[160:163], a[20:23]
    v_mfma_f32_16x16x32_bf16 a[24:27], v[124:127], v[164:167], a[24:27]
    v_mfma_f32_16x16x32_bf16 a[28:31], v[124:127], v[168:171], a[28:31]
    v_mfma_f32_16x16x32_bf16 a[32:35], v[128:131], v[156:159], a[32:35]
    v_mfma_f32_16x16x32_bf16 a[36:39], v[128:131], v[160:163], a[36:39]
    v_mfma_f32_16x16x32_bf16 a[40:43], v[128:131], v[164:167], a[40:43]
    v_mfma_f32_16x16x32_bf16 a[44:47], v[128:131], v[168:171], a[44:47]
    v_mfma_f32_16x16x32_bf16 a[48:51], v[132:135], v[156:159], a[48:51]
    v_mfma_f32_16x16x32_bf16 a[52:55], v[132:135], v[160:163], a[52:55]
    v_mfma_f32_16x16x32_bf16 a[56:59], v[132:135], v[164:167], a[56:59]
    v_mfma_f32_16x16x32_bf16 a[60:63], v[132:135], v[168:171], a[60:63]
    v_mfma_f32_16x16x32_bf16 a[64:67], v[136:139], v[156:159], a[64:67]
    v_mfma_f32_16x16x32_bf16 a[68:71], v[136:139], v[160:163], a[68:71]
    v_mfma_f32_16x16x32_bf16 a[72:75], v[136:139], v[164:167], a[72:75]
    v_mfma_f32_16x16x32_bf16 a[76:79], v[136:139], v[168:171], a[76:79]
    v_mfma_f32_16x16x32_bf16 a[80:83], v[140:143], v[156:159], a[80:83]
    v_mfma_f32_16x16x32_bf16 a[84:87], v[140:143], v[160:163], a[84:87]
    v_mfma_f32_16x16x32_bf16 a[88:91], v[140:143], v[164:167], a[88:91]
    v_mfma_f32_16x16x32_bf16 a[92:95], v[140:143], v[168:171], a[92:95]
    v_mfma_f32_16x16x32_bf16 a[96:99], v[144:147], v[156:159], a[96:99]
    v_mfma_f32_16x16x32_bf16 a[100:103], v[144:147], v[160:163], a[100:103]
    v_mfma_f32_16x16x32_bf16 a[104:107], v[144:147], v[164:167], a[104:107]
    v_mfma_f32_16x16x32_bf16 a[108:111], v[144:147], v[168:171], a[108:111]
    v_mfma_f32_16x16x32_bf16 a[112:115], v[148:151], v[156:159], a[112:115]
    v_mfma_f32_16x16x32_bf16 a[116:119], v[148:151], v[160:163], a[116:119]
    v_mfma_f32_16x16x32_bf16 a[120:123], v[148:151], v[164:167], a[120:123]
    v_mfma_f32_16x16x32_bf16 a[124:127], v[148:151], v[168:171], a[124:127]
    v_mfma_f32_16x16x32_bf16 a[128:131], v[152:155], v[156:159], a[128:131]
    v_mfma_f32_16x16x32_bf16 a[132:135], v[152:155], v[160:163], a[132:135]
    v_mfma_f32_16x16x32_bf16 a[136:139], v[152:155], v[164:167], a[136:139]
    v_mfma_f32_16x16x32_bf16 a[140:143], v[152:155], v[168:171], a[140:143]
    s_waitcnt vmcnt(0)
    v_mfma_f32_16x16x32_bf16 a[0:3], v[172:175], v[208:211], a[0:3]
    v_mfma_f32_16x16x32_bf16 a[4:7], v[172:175], v[212:215], a[4:7]
    v_mfma_f32_16x16x32_bf16 a[8:11], v[172:175], v[216:219], a[8:11]
    v_mfma_f32_16x16x32_bf16 a[12:15], v[172:175], v[220:223], a[12:15]
    v_mfma_f32_16x16x32_bf16 a[16:19], v[176:179], v[208:211], a[16:19]
    v_mfma_f32_16x16x32_bf16 a[20:23], v[176:179], v[212:215], a[20:23]
    v_mfma_f32_16x16x32_bf16 a[24:27], v[176:179], v[216:219], a[24:27]
    v_mfma_f32_16x16x32_bf16 a[28:31], v[176:179], v[220:223], a[28:31]
    v_mfma_f32_16x16x32_bf16 a[32:35], v[180:183], v[208:211], a[32:35]
    v_mfma_f32_16x16x32_bf16 a[36:39], v[180:183], v[212:215], a[36:39]
    v_mfma_f32_16x16x32_bf16 a[40:43], v[180:183], v[216:219], a[40:43]
    v_mfma_f32_16x16x32_bf16 a[44:47], v[180:183], v[220:223], a[44:47]
    v_mfma_f32_16x16x32_bf16 a[48:51], v[184:187], v[208:211], a[48:51]
    v_mfma_f32_16x16x32_bf16 a[52:55], v[184:187], v[212:215], a[52:55]
    v_mfma_f32_16x16x32_bf16 a[56:59], v[184:187], v[216:219], a[56:59]
    v_mfma_f32_16x16x32_bf16 a[60:63], v[184:187], v[220:223], a[60:63]
    v_mfma_f32_16x16x32_bf16 a[64:67], v[188:191], v[208:211], a[64:67]
    v_mfma_f32_16x16x32_bf16 a[68:71], v[188:191], v[212:215], a[68:71]
    v_mfma_f32_16x16x32_bf16 a[72:75], v[188:191], v[216:219], a[72:75]
    v_mfma_f32_16x16x32_bf16 a[76:79], v[188:191], v[220:223], a[76:79]
    v_mfma_f32_16x16x32_bf16 a[80:83], v[192:195], v[208:211], a[80:83]
    v_mfma_f32_16x16x32_bf16 a[84:87], v[192:195], v[212:215], a[84:87]
    v_mfma_f32_16x16x32_bf16 a[88:91], v[192:195], v[216:219], a[88:91]
    v_mfma_f32_16x16x32_bf16 a[92:95], v[192:195], v[220:223], a[92:95]
    v_mfma_f32_16x16x32_bf16 a[96:99], v[196:199], v[208:211], a[96:99]
    v_mfma_f32_16x16x32_bf16 a[100:103], v[196:199], v[212:215], a[100:103]
    v_mfma_f32_16x16x32_bf16 a[104:107], v[196:199], v[216:219], a[104:107]
    v_mfma_f32_16x16x32_bf16 a[108:111], v[196:199], v[220:223], a[108:111]
    v_mfma_f32_16x16x32_bf16 a[112:115], v[200:203], v[208:211], a[112:115]
    v_mfma_f32_16x16x32_bf16 a[116:119], v[200:203], v[212:215], a[116:119]
    v_mfma_f32_16x16x32_bf16 a[120:123], v[200:203], v[216:219], a[120:123]
    v_mfma_f32_16x16x32_bf16 a[124:127], v[200:203], v[220:223], a[124:127]
    v_mfma_f32_16x16x32_bf16 a[128:131], v[204:207], v[208:211], a[128:131]
    v_mfma_f32_16x16x32_bf16 a[132:135], v[204:207], v[212:215], a[132:135]
    v_mfma_f32_16x16x32_bf16 a[136:139], v[204:207], v[216:219], a[136:139]
    v_mfma_f32_16x16x32_bf16 a[140:143], v[204:207], v[220:223], a[140:143]
    v_and_b32 v8, 15, v2
    v_lshrrev_b32 v9, 4, v2
    v_mul_u32_u24 v8, 592, v8
    v_lshl_add_u32 v8, v9, 4, v8
    s_mul_i32 s28, s20, 37888
    v_add_u32 v8, s28, v8
    ds_write_b128 v8, a[0:3] offset:0
    ds_write_b128 v8, a[4:7] offset:9472
    ds_write_b128 v8, a[8:11] offset:18944
    ds_write_b128 v8, a[12:15] offset:28416
    ds_write_b128 v8, a[16:19] offset:64
    ds_write_b128 v8, a[20:23] offset:9536
    ds_write_b128 v8, a[24:27] offset:19008
    ds_write_b128 v8, a[28:31] offset:28480
    ds_write_b128 v8, a[32:35] offset:128
    ds_write_b128 v8, a[36:39] offset:9600
    ds_write_b128 v8, a[40:43] offset:19072
    ds_write_b128 v8, a[44:47] offset:28544
    ds_write_b128 v8, a[48:51] offset:192
    ds_write_b128 v8, a[52:55] offset:9664
    ds_write_b128 v8, a[56:59] offset:19136
    ds_write_b128 v8, a[60:63] offset:28608
    ds_write_b128 v8, a[64:67] offset:256
    ds_write_b128 v8, a[68:71] offset:9728
    ds_write_b128 v8, a[72:75] offset:19200
    ds_write_b128 v8, a[76:79] offset:28672
    ds_write_b128 v8, a[80:83] offset:320
    ds_write_b128 v8, a[84:87] offset:9792
    ds_write_b128 v8, a[88:91] offset:19264
    ds_write_b128 v8, a[92:95] offset:28736
    ds_write_b128 v8, a[96:99] offset:384
    ds_write_b128 v8, a[100:103] offset:9856
    ds_write_b128 v8, a[104:107] offset:19328
    ds_write_b128 v8, a[108:111] offset:28800
    ds_write_b128 v8, a[112:115] offset:448
    ds_write_b128 v8, a[116:119] offset:9920
    ds_write_b128 v8, a[120:123] offset:19392
    ds_write_b128 v8, a[124:127] offset:28864
    ds_write_b128 v8, a[128:131] offset:512
    ds_write_b128 v8, a[132:135] offset:9984
    ds_write_b128 v8, a[136:139] offset:19456
    ds_write_b128 v8, a[140:143] offset:28928
    s_waitcnt lgkmcnt(0)
    s_barrier
    v_lshrrev_b32 v9, 2, v0
    v_and_b32 v10, 3, v0
    v_mul_u32_u24 v11, 592, v9
    v_lshl_add_u32 v11, v10, 4, v11
    s_lshl_b32 s28, s22, 6
    v_add_u32 v12, s28, v9
    v_mul_u32_u24 v12, 2304, v12
    v_lshl_add_u32 v12, v10, 3, v12
    s_mul_i32 s28, s21, 1152
    s_mul_i32 s29, s23, 288
    s_add_u32 s28, s28, s29
    v_add_u32 v13, 75776, v11
    ds_read_b128 v[16:19], v11 offset:0
    ds_read_b128 v[20:23], v11 offset:37888
    ds_read_b128 v[24:27], v13 offset:0
    ds_read_b128 v[28:31], v13 offset:37888
    s_waitcnt lgkmcnt(0)
    v_add_f32 v16, v16, v20
    v_add_f32 v24, v24, v28
    v_add_f32 v17, v17, v21
    v_add_f32 v25, v25, v29
    v_add_f32 v18, v18, v22
    v_add_f32 v26, v26, v30
    v_add_f32 v19, v19, v23
    v_add_f32 v27, v27, v31
    v_add_f32 v16, v16, v24
    v_add_f32 v17, v17, v25
    v_add_f32 v18, v18, v26
    v_add_f32 v19, v19, v27
    v_cvt_pk_bf16_f32 v20, v16, v17
    v_cvt_pk_bf16_f32 v21, v18, v19
    buffer_store_dwordx2 v[20:21], v12, s[16:19], s28 offen offset:0
    ds_read_b128 v[32:35], v11 offset:64
    ds_read_b128 v[36:39], v11 offset:37952
    ds_read_b128 v[40:43], v13 offset:64
    ds_read_b128 v[44:47], v13 offset:37952
    s_waitcnt lgkmcnt(0)
    v_add_f32 v32, v32, v36
    v_add_f32 v40, v40, v44
    v_add_f32 v33, v33, v37
    v_add_f32 v41, v41, v45
    v_add_f32 v34, v34, v38
    v_add_f32 v42, v42, v46
    v_add_f32 v35, v35, v39
    v_add_f32 v43, v43, v47
    v_add_f32 v32, v32, v40
    v_add_f32 v33, v33, v41
    v_add_f32 v34, v34, v42
    v_add_f32 v35, v35, v43
    v_cvt_pk_bf16_f32 v36, v32, v33
    v_cvt_pk_bf16_f32 v37, v34, v35
    buffer_store_dwordx2 v[36:37], v12, s[16:19], s28 offen offset:32
    ds_read_b128 v[48:51], v11 offset:128
    ds_read_b128 v[52:55], v11 offset:38016
    ds_read_b128 v[56:59], v13 offset:128
    ds_read_b128 v[60:63], v13 offset:38016
    s_waitcnt lgkmcnt(0)
    v_add_f32 v48, v48, v52
    v_add_f32 v56, v56, v60
    v_add_f32 v49, v49, v53
    v_add_f32 v57, v57, v61
    v_add_f32 v50, v50, v54
    v_add_f32 v58, v58, v62
    v_add_f32 v51, v51, v55
    v_add_f32 v59, v59, v63
    v_add_f32 v48, v48, v56
    v_add_f32 v49, v49, v57
    v_add_f32 v50, v50, v58
    v_add_f32 v51, v51, v59
    v_cvt_pk_bf16_f32 v52, v48, v49
    v_cvt_pk_bf16_f32 v53, v50, v51
    buffer_store_dwordx2 v[52:53], v12, s[16:19], s28 offen offset:64
    ds_read_b128 v[16:19], v11 offset:192
    ds_read_b128 v[20:23], v11 offset:38080
    ds_read_b128 v[24:27], v13 offset:192
    ds_read_b128 v[28:31], v13 offset:38080
    s_waitcnt lgkmcnt(0)
    v_add_f32 v16, v16, v20
    v_add_f32 v24, v24, v28
    v_add_f32 v17, v17, v21
    v_add_f32 v25, v25, v29
    v_add_f32 v18, v18, v22
    v_add_f32 v26, v26, v30
    v_add_f32 v19, v19, v23
    v_add_f32 v27, v27, v31
    v_add_f32 v16, v16, v24
    v_add_f32 v17, v17, v25
    v_add_f32 v18, v18, v26
    v_add_f32 v19, v19, v27
    v_cvt_pk_bf16_f32 v20, v16, v17
    v_cvt_pk_bf16_f32 v21, v18, v19
    buffer_store_dwordx2 v[20:21], v12, s[16:19], s28 offen offset:96
    ds_read_b128 v[32:35], v11 offset:256
    ds_read_b128 v[36:39], v11 offset:38144
    ds_read_b128 v[40:43], v13 offset:256
    ds_read_b128 v[44:47], v13 offset:38144
    s_waitcnt lgkmcnt(0)
    v_add_f32 v32, v32, v36
    v_add_f32 v40, v40, v44
    v_add_f32 v33, v33, v37
    v_add_f32 v41, v41, v45
    v_add_f32 v34, v34, v38
    v_add_f32 v42, v42, v46
    v_add_f32 v35, v35, v39
    v_add_f32 v43, v43, v47
    v_add_f32 v32, v32, v40
    v_add_f32 v33, v33, v41
    v_add_f32 v34, v34, v42
    v_add_f32 v35, v35, v43
    v_cvt_pk_bf16_f32 v36, v32, v33
    v_cvt_pk_bf16_f32 v37, v34, v35
    buffer_store_dwordx2 v[36:37], v12, s[16:19], s28 offen offset:128
    ds_read_b128 v[48:51], v11 offset:320
    ds_read_b128 v[52:55], v11 offset:38208
    ds_read_b128 v[56:59], v13 offset:320
    ds_read_b128 v[60:63], v13 offset:38208
    s_waitcnt lgkmcnt(0)
    v_add_f32 v48, v48, v52
    v_add_f32 v56, v56, v60
    v_add_f32 v49, v49, v53
    v_add_f32 v57, v57, v61
    v_add_f32 v50, v50, v54
    v_add_f32 v58, v58, v62
    v_add_f32 v51, v51, v55
    v_add_f32 v59, v59, v63
    v_add_f32 v48, v48, v56
    v_add_f32 v49, v49, v57
    v_add_f32 v50, v50, v58
    v_add_f32 v51, v51, v59
    v_cvt_pk_bf16_f32 v52, v48, v49
    v_cvt_pk_bf16_f32 v53, v50, v51
    buffer_store_dwordx2 v[52:53], v12, s[16:19], s28 offen offset:160
    ds_read_b128 v[16:19], v11 offset:384
    ds_read_b128 v[20:23], v11 offset:38272
    ds_read_b128 v[24:27], v13 offset:384
    ds_read_b128 v[28:31], v13 offset:38272
    s_waitcnt lgkmcnt(0)
    v_add_f32 v16, v16, v20
    v_add_f32 v24, v24, v28
    v_add_f32 v17, v17, v21
    v_add_f32 v25, v25, v29
    v_add_f32 v18, v18, v22
    v_add_f32 v26, v26, v30
    v_add_f32 v19, v19, v23
    v_add_f32 v27, v27, v31
    v_add_f32 v16, v16, v24
    v_add_f32 v17, v17, v25
    v_add_f32 v18, v18, v26
    v_add_f32 v19, v19, v27
    v_cvt_pk_bf16_f32 v20, v16, v17
    v_cvt_pk_bf16_f32 v21, v18, v19
    buffer_store_dwordx2 v[20:21], v12, s[16:19], s28 offen offset:192
    ds_read_b128 v[32:35], v11 offset:448
    ds_read_b128 v[36:39], v11 offset:38336
    ds_read_b128 v[40:43], v13 offset:448
    ds_read_b128 v[44:47], v13 offset:38336
    s_waitcnt lgkmcnt(0)
    v_add_f32 v32, v32, v36
    v_add_f32 v40, v40, v44
    v_add_f32 v33, v33, v37
    v_add_f32 v41, v41, v45
    v_add_f32 v34, v34, v38
    v_add_f32 v42, v42, v46
    v_add_f32 v35, v35, v39
    v_add_f32 v43, v43, v47
    v_add_f32 v32, v32, v40
    v_add_f32 v33, v33, v41
    v_add_f32 v34, v34, v42
    v_add_f32 v35, v35, v43
    v_cvt_pk_bf16_f32 v36, v32, v33
    v_cvt_pk_bf16_f32 v37, v34, v35
    buffer_store_dwordx2 v[36:37], v12, s[16:19], s28 offen offset:224
    ds_read_b128 v[48:51], v11 offset:512
    ds_read_b128 v[52:55], v11 offset:38400
    ds_read_b128 v[56:59], v13 offset:512
    ds_read_b128 v[60:63], v13 offset:38400
    s_waitcnt lgkmcnt(0)
    v_add_f32 v48, v48, v52
    v_add_f32 v56, v56, v60
    v_add_f32 v49, v49, v53
    v_add_f32 v57, v57, v61
    v_add_f32 v50, v50, v54
    v_add_f32 v58, v58, v62
    v_add_f32 v51, v51, v55
    v_add_f32 v59, v59, v63
    v_add_f32 v48, v48, v56
    v_add_f32 v49, v49, v57
    v_add_f32 v50, v50, v58
    v_add_f32 v51, v51, v59
    v_cvt_pk_bf16_f32 v52, v48, v49
    v_cvt_pk_bf16_f32 v53, v50, v51
    buffer_store_dwordx2 v[52:53], v12, s[16:19], s28 offen offset:256
Lop_done:
    s_endpgm
.section .rodata,"a"
.p2align 6
.amdhsa_kernel attn_kernel
  .amdhsa_next_free_vgpr 256
  .amdhsa_next_free_sgpr 102
  .amdhsa_accum_offset 256
  .amdhsa_group_segment_fixed_size 0
  .amdhsa_kernarg_size 104
  .amdhsa_user_sgpr_count 2
  .amdhsa_user_sgpr_kernarg_segment_ptr 1
  .amdhsa_system_sgpr_workgroup_id_x 1
.end_amdhsa_kernel
.p2align 6
.amdhsa_kernel outproj_kernel
  .amdhsa_next_free_vgpr 400
  .amdhsa_next_free_sgpr 102
  .amdhsa_accum_offset 256
  .amdhsa_group_segment_fixed_size 0
  .amdhsa_kernarg_size 104
  .amdhsa_user_sgpr_count 2
  .amdhsa_user_sgpr_kernarg_segment_ptr 1
  .amdhsa_system_sgpr_workgroup_id_x 1
.end_amdhsa_kernel
```
